```python
import torch

def _softmax(x, axis=-1):
    return torch.softmax(x, dim=axis)
def _gelu(x):
    return torch.nn.functional.gelu(x, approximate="tanh")
def _silu(x):
    return torch.nn.functional.silu(x)
def _sigmoid(x):
    return torch.sigmoid(x)
def _layernorm(x, axis=-1, eps=1e-5):
    m = x.mean(dim=axis, keepdim=True)
    v = x.var(dim=axis, keepdim=True, unbiased=False)
    return (x - m) / torch.sqrt(v + eps)
def _scatter_add(tgt, idx, src, axis=0):
    return tgt.clone().index_add_(axis, idx, src)
def _segment_sum(src, seg, n):
    out = torch.zeros((n,) + src.shape[1:], dtype=src.dtype)
    return out.index_add_(0, seg, src)
def _pad(x, pw):
    flat = tuple(v for pair in reversed(pw) for v in pair)
    return torch.nn.functional.pad(x, flat)

kernel_name = 'parallel_sum__compressed_kv_cla__mixer_token_mlp__prompt'

def setup_inputs():

    _w = (lambda a: (lambda t: t.to(torch.bfloat16) if t.is_floating_point() else t)(torch.as_tensor(a)))
    def _A_setup():
        B, H, Sq, Sk, D, M = 1, 32, 2048, 2048, 128, 640
        Dc = 4 * D
        return {
            "x": _w((lambda *s: torch.randn(*s, dtype=torch.bfloat16) * 0.05)(B, Sq, M)),
            "c_kv": _w((lambda *s: torch.randn(*s, dtype=torch.bfloat16) * 0.2)(B, Sk, Dc)),
            "w_q": _w((lambda *s: torch.randn(*s, dtype=torch.bfloat16) * 6.4)(M, H, D) * (M ** -0.5)),
            "w_uk": _w((lambda *s: torch.randn(*s, dtype=torch.bfloat16) * 6.4)(Dc, H, D) * (Dc ** -0.5)),
            "w_uv": _w((lambda *s: torch.randn(*s, dtype=torch.bfloat16) * 0.2)(Dc, H, D) * (Dc ** -0.5)),
            "w_o": _w((lambda *s: torch.randn(*s, dtype=torch.bfloat16) * 0.2)(H, D, M) * ((H * D) ** -0.5)),
        }
    _A_in = _A_setup()

    def _B_setup():
        B, S, D, F = 1, 2048, 640, 1728
        return {
            "x": _w((lambda *s: torch.randn(*s, dtype=torch.bfloat16) * 0.05)(B, S, D)),
            "w1": _w((lambda *s: torch.randn(*s, dtype=torch.bfloat16) * 0.4)(S, F) * (S ** -0.5)),
            "b1": _w((lambda *s: torch.randn(*s, dtype=torch.bfloat16) * 3.2)(F) * 0.02),
            "w2": _w((lambda *s: torch.randn(*s, dtype=torch.bfloat16) * 0.2)(F, S) * (F ** -0.5)),
            "b2": _w((lambda *s: torch.randn(*s, dtype=torch.bfloat16) * 0.8)(S) * 0.02),
        }
    _B_in = _B_setup()

    return {
        "A_x": _A_in["x"],
        "A_c_kv": _A_in["c_kv"],
        "A_w_q": _A_in["w_q"],
        "A_w_uk": _A_in["w_uk"],
        "A_w_uv": _A_in["w_uv"],
        "A_w_o": _A_in["w_o"],
        "B_x": _B_in["x"],
        "B_w1": _B_in["w1"],
        "B_b1": _B_in["b1"],
        "B_w2": _B_in["w2"],
        "B_b2": _B_in["b2"],
    }

def reference(A_x, A_c_kv, A_w_q, A_w_uk, A_w_uv, A_w_o, B_x, B_w1, B_b1, B_w2, B_b2):
    def _A_ref(x, c_kv, w_q, w_uk, w_uv, w_o):
        B, Sq, M = x.shape[0], x.shape[1], x.shape[2]
        Sk = c_kv.shape[1]
        H, D = w_q.shape[1], w_q.shape[2]
        q = torch.einsum("bqm,mhd->bhqd", x, w_q)
        k = torch.einsum("bkc,chd->bhkd", c_kv, w_uk)
        v = torch.einsum("bkc,chd->bhkd", c_kv, w_uv)
        scores = torch.einsum("bhqd,bhkd->bhqk", q, k) * (D ** -0.5)
        off = Sk - Sq
        qi = torch.arange(Sq)[:, None]
        kj = torch.arange(Sk)[None, :]
        cmask = kj <= (qi + off)
        scores = torch.where(cmask[None, None], scores, -1e9)
        p = _softmax(scores, axis=-1)
        ctx = torch.einsum("bhqk,bhkd->bhqd", p, v)
        return torch.einsum("bhqd,hdm->bqm", ctx, w_o)

    def _B_ref(x, w1, b1, w2, b2):
        B, S, D = x.shape
        h = _layernorm(x, axis=-1)
        u = torch.einsum("bsd,sf->bdf", h, w1) + b1
        u = _gelu(u)
        y = torch.einsum("bdf,fs->bds", u, w2) + b2
        return (lambda x, *d: x.permute(*d))(y, 0, 2, 1)

    x = A_x
    xn = _layernorm(x, axis=-1)
    return x + _A_ref(xn, A_c_kv, A_w_q, A_w_uk, A_w_uv, A_w_o) + _B_ref(xn, B_w1, B_b1, B_w2, B_b2)
```

```asm
; @launch kernel=ln_kernel grid=(1024,1,1) block=(256,1,1) lds=0
; @launch kernel=proj_kernel grid=(419,1,1) block=(512,1,1) lds=131072
; @launch kernel=attn_kernel grid=(256,1,1) block=(512,1,1) lds=163840
; @launch kernel=final_kernel grid=(240,1,1) block=(512,1,1) lds=131072
; @launch kernel=reduce_kernel grid=(640,1,1) block=(256,1,1) lds=0
.amdgcn_target "amdgcn-amd-amdhsa--gfx950"
.text
.globl ln_kernel
.p2align 8
.type ln_kernel,@function
ln_kernel:
    s_cmp_ge_u32 s2, 1024
    s_cbranch_scc1 ln_end
    s_cmp_ge_u32 s2, 512
    s_cbranch_scc1 ln_pf
    s_load_dwordx2 s[4:5], s[0:1], 0
    s_load_dwordx2 s[6:7], s[0:1], 104
    v_lshrrev_b32 v1, 6, v0
    v_and_b32 v2, 63, v0
    s_lshl_b32 s3, s2, 2
    v_add_u32 v1, s3, v1
    s_movk_i32 s16, 1280
    v_mul_lo_u32 v1, v1, s16
    v_lshl_add_u32 v1, v2, 2, v1
    s_waitcnt lgkmcnt(0)
    s_mov_b32 s8, s4
    s_mov_b32 s9, s5
    s_mov_b32 s10, 0x280000
    s_mov_b32 s11, 0x00020000
    s_mov_b32 s12, s6
    s_mov_b32 s13, s7
    s_mov_b32 s14, 0x500000
    s_mov_b32 s15, 0x00020000
    buffer_load_dword v4, v1, s[8:11], 0 offen offset:0
    buffer_load_dword v5, v1, s[8:11], 0 offen offset:256
    buffer_load_dword v6, v1, s[8:11], 0 offen offset:512
    buffer_load_dword v7, v1, s[8:11], 0 offen offset:768
    buffer_load_dword v8, v1, s[8:11], 0 offen offset:1024
    s_waitcnt vmcnt(0)
    s_mov_b32 s17, 0x3acccccd
    s_mov_b32 s18, 0x3727c5ac
    s_mov_b32 s19, 0xffff0000
    v_lshlrev_b32 v10, 16, v4
    v_and_b32 v11, s19, v4
    v_lshlrev_b32 v12, 16, v5
    v_and_b32 v13, s19, v5
    v_lshlrev_b32 v14, 16, v6
    v_and_b32 v15, s19, v6
    v_lshlrev_b32 v16, 16, v7
    v_and_b32 v17, s19, v7
    v_lshlrev_b32 v18, 16, v8
    v_and_b32 v19, s19, v8
    v_add_f32 v20, v10, v11
    v_add_f32 v20, v20, v12
    v_add_f32 v20, v20, v13
    v_add_f32 v20, v20, v14
    v_add_f32 v20, v20, v15
    v_add_f32 v20, v20, v16
    v_add_f32 v20, v20, v17
    v_add_f32 v20, v20, v18
    v_add_f32 v20, v20, v19
    ds_swizzle_b32 v21, v20 offset:0x041F
    s_waitcnt lgkmcnt(0)
    v_add_f32 v20, v20, v21
    ds_swizzle_b32 v21, v20 offset:0x081F
    s_waitcnt lgkmcnt(0)
    v_add_f32 v20, v20, v21
    ds_swizzle_b32 v21, v20 offset:0x101F
    s_waitcnt lgkmcnt(0)
    v_add_f32 v20, v20, v21
    ds_swizzle_b32 v21, v20 offset:0x201F
    s_waitcnt lgkmcnt(0)
    v_add_f32 v20, v20, v21
    ds_swizzle_b32 v21, v20 offset:0x401F
    s_waitcnt lgkmcnt(0)
    v_add_f32 v20, v20, v21
    v_mov_b32 v21, v20
    s_nop 1
    v_permlane32_swap_b32 v21, v20
    s_nop 1
    v_add_f32 v20, v20, v21
    v_mul_f32 v20, s17, v20
    v_sub_f32 v10, v10, v20
    v_sub_f32 v11, v11, v20
    v_sub_f32 v12, v12, v20
    v_sub_f32 v13, v13, v20
    v_sub_f32 v14, v14, v20
    v_sub_f32 v15, v15, v20
    v_sub_f32 v16, v16, v20
    v_sub_f32 v17, v17, v20
    v_sub_f32 v18, v18, v20
    v_sub_f32 v19, v19, v20
    v_mul_f32 v22, v10, v10
    v_fmac_f32 v22, v11, v11
    v_fmac_f32 v22, v12, v12
    v_fmac_f32 v22, v13, v13
    v_fmac_f32 v22, v14, v14
    v_fmac_f32 v22, v15, v15
    v_fmac_f32 v22, v16, v16
    v_fmac_f32 v22, v17, v17
    v_fmac_f32 v22, v18, v18
    v_fmac_f32 v22, v19, v19
    ds_swizzle_b32 v21, v22 offset:0x041F
    s_waitcnt lgkmcnt(0)
    v_add_f32 v22, v22, v21
    ds_swizzle_b32 v21, v22 offset:0x081F
    s_waitcnt lgkmcnt(0)
    v_add_f32 v22, v22, v21
    ds_swizzle_b32 v21, v22 offset:0x101F
    s_waitcnt lgkmcnt(0)
    v_add_f32 v22, v22, v21
    ds_swizzle_b32 v21, v22 offset:0x201F
    s_waitcnt lgkmcnt(0)
    v_add_f32 v22, v22, v21
    ds_swizzle_b32 v21, v22 offset:0x401F
    s_waitcnt lgkmcnt(0)
    v_add_f32 v22, v22, v21
    v_mov_b32 v21, v22
    s_nop 1
    v_permlane32_swap_b32 v21, v22
    s_nop 1
    v_add_f32 v22, v22, v21
    v_mov_b32 v23, s18
    v_fmac_f32 v23, s17, v22
    v_rsq_f32 v23, v23
    s_nop 1
    v_mul_f32 v10, v10, v23
    v_mul_f32 v11, v11, v23
    v_mul_f32 v12, v12, v23
    v_mul_f32 v13, v13, v23
    v_mul_f32 v14, v14, v23
    v_mul_f32 v15, v15, v23
    v_mul_f32 v16, v16, v23
    v_mul_f32 v17, v17, v23
    v_mul_f32 v18, v18, v23
    v_mul_f32 v19, v19, v23
    v_cvt_pk_bf16_f32 v4, v10, v11
    v_cvt_pk_bf16_f32 v5, v12, v13
    v_cvt_pk_bf16_f32 v6, v14, v15
    v_cvt_pk_bf16_f32 v7, v16, v17
    v_cvt_pk_bf16_f32 v8, v18, v19
    s_mov_b32 s20, 0x0
    buffer_store_dword v4, v1, s[12:15], s20 offen offset:0
    buffer_store_dword v5, v1, s[12:15], s20 offen offset:256
    buffer_store_dword v6, v1, s[12:15], s20 offen offset:512
    buffer_store_dword v7, v1, s[12:15], s20 offen offset:768
    buffer_store_dword v8, v1, s[12:15], s20 offen offset:1024
    s_nop 4
    v_lshlrev_b32 v10, 16, v4
    v_and_b32 v11, s19, v4
    v_lshlrev_b32 v12, 16, v5
    v_and_b32 v13, s19, v5
    v_lshlrev_b32 v14, 16, v6
    v_and_b32 v15, s19, v6
    v_lshlrev_b32 v16, 16, v7
    v_and_b32 v17, s19, v7
    v_lshlrev_b32 v18, 16, v8
    v_and_b32 v19, s19, v8
    v_add_f32 v20, v10, v11
    v_add_f32 v20, v20, v12
    v_add_f32 v20, v20, v13
    v_add_f32 v20, v20, v14
    v_add_f32 v20, v20, v15
    v_add_f32 v20, v20, v16
    v_add_f32 v20, v20, v17
    v_add_f32 v20, v20, v18
    v_add_f32 v20, v20, v19
    ds_swizzle_b32 v21, v20 offset:0x041F
    s_waitcnt lgkmcnt(0)
    v_add_f32 v20, v20, v21
    ds_swizzle_b32 v21, v20 offset:0x081F
    s_waitcnt lgkmcnt(0)
    v_add_f32 v20, v20, v21
    ds_swizzle_b32 v21, v20 offset:0x101F
    s_waitcnt lgkmcnt(0)
    v_add_f32 v20, v20, v21
    ds_swizzle_b32 v21, v20 offset:0x201F
    s_waitcnt lgkmcnt(0)
    v_add_f32 v20, v20, v21
    ds_swizzle_b32 v21, v20 offset:0x401F
    s_waitcnt lgkmcnt(0)
    v_add_f32 v20, v20, v21
    v_mov_b32 v21, v20
    s_nop 1
    v_permlane32_swap_b32 v21, v20
    s_nop 1
    v_add_f32 v20, v20, v21
    v_mul_f32 v20, s17, v20
    v_sub_f32 v10, v10, v20
    v_sub_f32 v11, v11, v20
    v_sub_f32 v12, v12, v20
    v_sub_f32 v13, v13, v20
    v_sub_f32 v14, v14, v20
    v_sub_f32 v15, v15, v20
    v_sub_f32 v16, v16, v20
    v_sub_f32 v17, v17, v20
    v_sub_f32 v18, v18, v20
    v_sub_f32 v19, v19, v20
    v_mul_f32 v22, v10, v10
    v_fmac_f32 v22, v11, v11
    v_fmac_f32 v22, v12, v12
    v_fmac_f32 v22, v13, v13
    v_fmac_f32 v22, v14, v14
    v_fmac_f32 v22, v15, v15
    v_fmac_f32 v22, v16, v16
    v_fmac_f32 v22, v17, v17
    v_fmac_f32 v22, v18, v18
    v_fmac_f32 v22, v19, v19
    ds_swizzle_b32 v21, v22 offset:0x041F
    s_waitcnt lgkmcnt(0)
    v_add_f32 v22, v22, v21
    ds_swizzle_b32 v21, v22 offset:0x081F
    s_waitcnt lgkmcnt(0)
    v_add_f32 v22, v22, v21
    ds_swizzle_b32 v21, v22 offset:0x101F
    s_waitcnt lgkmcnt(0)
    v_add_f32 v22, v22, v21
    ds_swizzle_b32 v21, v22 offset:0x201F
    s_waitcnt lgkmcnt(0)
    v_add_f32 v22, v22, v21
    ds_swizzle_b32 v21, v22 offset:0x401F
    s_waitcnt lgkmcnt(0)
    v_add_f32 v22, v22, v21
    v_mov_b32 v21, v22
    s_nop 1
    v_permlane32_swap_b32 v21, v22
    s_nop 1
    v_add_f32 v22, v22, v21
    v_mov_b32 v23, s18
    v_fmac_f32 v23, s17, v22
    v_rsq_f32 v23, v23
    s_nop 1
    v_mul_f32 v10, v10, v23
    v_mul_f32 v11, v11, v23
    v_mul_f32 v12, v12, v23
    v_mul_f32 v13, v13, v23
    v_mul_f32 v14, v14, v23
    v_mul_f32 v15, v15, v23
    v_mul_f32 v16, v16, v23
    v_mul_f32 v17, v17, v23
    v_mul_f32 v18, v18, v23
    v_mul_f32 v19, v19, v23
    v_cvt_pk_bf16_f32 v4, v10, v11
    v_cvt_pk_bf16_f32 v5, v12, v13
    v_cvt_pk_bf16_f32 v6, v14, v15
    v_cvt_pk_bf16_f32 v7, v16, v17
    v_cvt_pk_bf16_f32 v8, v18, v19
    s_mov_b32 s20, 0x280000
    buffer_store_dword v4, v1, s[12:15], s20 offen offset:0
    buffer_store_dword v5, v1, s[12:15], s20 offen offset:256
    buffer_store_dword v6, v1, s[12:15], s20 offen offset:512
    buffer_store_dword v7, v1, s[12:15], s20 offen offset:768
    buffer_store_dword v8, v1, s[12:15], s20 offen offset:1024
    s_endpgm
ln_pf:
    s_load_dwordx2 s[32:33], s[0:1], 8
    s_load_dwordx2 s[34:35], s[0:1], 16
    s_load_dwordx2 s[36:37], s[0:1], 24
    s_load_dwordx2 s[38:39], s[0:1], 32
    s_load_dwordx2 s[40:41], s[0:1], 56
    s_load_dwordx2 s[42:43], s[0:1], 40
    s_load_dwordx2 s[44:45], s[0:1], 72
    s_sub_u32 s3, s2, 512
    s_lshl_b32 s3, s3, 12
    v_lshlrev_b32 v1, 4, v0
    v_add_u32 v1, s3, v1
    s_waitcnt lgkmcnt(0)
    s_mov_b32 s8, s32
    s_mov_b32 s9, s33
    s_mov_b32 s10, 0x200000
    s_mov_b32 s11, 0x00020000
    s_mov_b32 s20, 0
    buffer_load_dwordx4 v[4:7], v1, s[8:11], s20 offen
    s_mov_b32 s8, s34
    s_mov_b32 s9, s35
    s_mov_b32 s10, 0x500000
    s_mov_b32 s11, 0x00020000
    s_mov_b32 s20, 0
    buffer_load_dwordx4 v[8:11], v1, s[8:11], s20 offen
    s_mov_b32 s20, 2097152
    buffer_load_dwordx4 v[12:15], v1, s[8:11], s20 offen
    s_mov_b32 s20, 4194304
    buffer_load_dwordx4 v[16:19], v1, s[8:11], s20 offen
    s_mov_b32 s8, s36
    s_mov_b32 s9, s37
    s_mov_b32 s10, 0x400000
    s_mov_b32 s11, 0x00020000
    s_mov_b32 s20, 0
    buffer_load_dwordx4 v[20:23], v1, s[8:11], s20 offen
    s_mov_b32 s20, 2097152
    buffer_load_dwordx4 v[24:27], v1, s[8:11], s20 offen
    s_mov_b32 s8, s38
    s_mov_b32 s9, s39
    s_mov_b32 s10, 0x400000
    s_mov_b32 s11, 0x00020000
    s_mov_b32 s20, 0
    buffer_load_dwordx4 v[4:7], v1, s[8:11], s20 offen
    s_mov_b32 s20, 2097152
    buffer_load_dwordx4 v[8:11], v1, s[8:11], s20 offen
    s_mov_b32 s8, s40
    s_mov_b32 s9, s41
    s_mov_b32 s10, 0x6c0000
    s_mov_b32 s11, 0x00020000
    s_mov_b32 s20, 0
    buffer_load_dwordx4 v[12:15], v1, s[8:11], s20 offen
    s_mov_b32 s20, 2097152
    buffer_load_dwordx4 v[16:19], v1, s[8:11], s20 offen
    s_mov_b32 s20, 4194304
    buffer_load_dwordx4 v[20:23], v1, s[8:11], s20 offen
    s_mov_b32 s20, 6291456
    buffer_load_dwordx4 v[24:27], v1, s[8:11], s20 offen
    s_mov_b32 s8, s42
    s_mov_b32 s9, s43
    s_mov_b32 s10, 0x500000
    s_mov_b32 s11, 0x00020000
    s_mov_b32 s20, 0
    buffer_load_dwordx4 v[4:7], v1, s[8:11], s20 offen
    s_mov_b32 s20, 2097152
    buffer_load_dwordx4 v[8:11], v1, s[8:11], s20 offen
    s_mov_b32 s20, 4194304
    buffer_load_dwordx4 v[12:15], v1, s[8:11], s20 offen
    s_mov_b32 s8, s44
    s_mov_b32 s9, s45
    s_mov_b32 s10, 0x6c0000
    s_mov_b32 s11, 0x00020000
    s_mov_b32 s20, 0
    buffer_load_dwordx4 v[16:19], v1, s[8:11], s20 offen
    s_mov_b32 s20, 2097152
    buffer_load_dwordx4 v[20:23], v1, s[8:11], s20 offen
    s_mov_b32 s20, 4194304
    buffer_load_dwordx4 v[24:27], v1, s[8:11], s20 offen
    s_mov_b32 s20, 6291456
    buffer_load_dwordx4 v[4:7], v1, s[8:11], s20 offen
    s_waitcnt vmcnt(0)
ln_end:
    s_endpgm
.text
.globl proj_kernel
.p2align 8
.type proj_kernel,@function
proj_kernel:
    s_cmp_ge_u32 s2, 419
    s_cbranch_scc1 p1_end
    s_load_dwordx2 s[32:33], s[0:1], 8
    s_load_dwordx2 s[34:35], s[0:1], 16
    s_load_dwordx2 s[36:37], s[0:1], 24
    s_load_dwordx2 s[38:39], s[0:1], 32
    s_load_dwordx2 s[40:41], s[0:1], 56
    s_load_dwordx2 s[42:43], s[0:1], 64
    s_load_dwordx2 s[44:45], s[0:1], 104
    s_waitcnt lgkmcnt(0)
    s_cmp_lt_u32 s2, 35
    s_cbranch_scc1 p1_u
    s_cmp_lt_u32 s2, 163
    s_cbranch_scc1 p1_q
    s_cmp_lt_u32 s2, 291
    s_cbranch_scc1 p1_k
    s_branch p1_v
p1_q:
    s_mov_b32 s4, s34
    s_mov_b32 s5, s35
    s_mov_b32 s6, 0x500000
    s_mov_b32 s7, 0x00020000
    s_mov_b32 s8, s44
    s_mov_b32 s9, s45
    s_mov_b32 s10, 0x280000
    s_mov_b32 s11, 0x00020000
    s_add_u32 s12, s44, 0x1000000
    s_addc_u32 s13, s45, 0
    s_mov_b32 s14, 0x1000000
    s_mov_b32 s15, 0x00020000
    s_sub_u32 s3, s2, 35
    s_and_b32 s46, s3, 15
    s_lshr_b32 s47, s3, 4
    s_lshl_b32 s46, s46, 8
    s_lshl_b32 s47, s47, 8
    s_lshl_b32 s48, s46, 1
    s_mul_i32 s49, s47, 1280
    v_and_b32 v2, 63, v0
    v_lshrrev_b32 v3, 6, v0
    s_nop 0
    v_readfirstlane_b32 s20, v3
    s_nop 3
    s_and_b32 s28, s20, 1
    s_lshr_b32 s29, s20, 1
    v_mov_b32 v72, 0
    v_mov_b32 v73, 0
    v_mov_b32 v74, 0
    v_mov_b32 v75, 0
    v_mov_b32 v76, 0
    v_mov_b32 v77, 0
    v_mov_b32 v78, 0
    v_mov_b32 v79, 0
    v_mov_b32 v80, 0
    v_mov_b32 v81, 0
    v_mov_b32 v82, 0
    v_mov_b32 v83, 0
    v_mov_b32 v84, 0
    v_mov_b32 v85, 0
    v_mov_b32 v86, 0
    v_mov_b32 v87, 0
    v_mov_b32 v88, 0
    v_mov_b32 v89, 0
    v_mov_b32 v90, 0
    v_mov_b32 v91, 0
    v_mov_b32 v92, 0
    v_mov_b32 v93, 0
    v_mov_b32 v94, 0
    v_mov_b32 v95, 0
    v_mov_b32 v96, 0
    v_mov_b32 v97, 0
    v_mov_b32 v98, 0
    v_mov_b32 v99, 0
    v_mov_b32 v100, 0
    v_mov_b32 v101, 0
    v_mov_b32 v102, 0
    v_mov_b32 v103, 0
    v_mov_b32 v104, 0
    v_mov_b32 v105, 0
    v_mov_b32 v106, 0
    v_mov_b32 v107, 0
    v_mov_b32 v108, 0
    v_mov_b32 v109, 0
    v_mov_b32 v110, 0
    v_mov_b32 v111, 0
    v_mov_b32 v112, 0
    v_mov_b32 v113, 0
    v_mov_b32 v114, 0
    v_mov_b32 v115, 0
    v_mov_b32 v116, 0
    v_mov_b32 v117, 0
    v_mov_b32 v118, 0
    v_mov_b32 v119, 0
    v_mov_b32 v120, 0
    v_mov_b32 v121, 0
    v_mov_b32 v122, 0
    v_mov_b32 v123, 0
    v_mov_b32 v124, 0
    v_mov_b32 v125, 0
    v_mov_b32 v126, 0
    v_mov_b32 v127, 0
    v_mov_b32 v128, 0
    v_mov_b32 v129, 0
    v_mov_b32 v130, 0
    v_mov_b32 v131, 0
    v_mov_b32 v132, 0
    v_mov_b32 v133, 0
    v_mov_b32 v134, 0
    v_mov_b32 v135, 0
    v_mov_b32 v136, 0
    v_mov_b32 v137, 0
    v_mov_b32 v138, 0
    v_mov_b32 v139, 0
    v_mov_b32 v140, 0
    v_mov_b32 v141, 0
    v_mov_b32 v142, 0
    v_mov_b32 v143, 0
    v_mov_b32 v144, 0
    v_mov_b32 v145, 0
    v_mov_b32 v146, 0
    v_mov_b32 v147, 0
    v_mov_b32 v148, 0
    v_mov_b32 v149, 0
    v_mov_b32 v150, 0
    v_mov_b32 v151, 0
    v_mov_b32 v152, 0
    v_mov_b32 v153, 0
    v_mov_b32 v154, 0
    v_mov_b32 v155, 0
    v_mov_b32 v156, 0
    v_mov_b32 v157, 0
    v_mov_b32 v158, 0
    v_mov_b32 v159, 0
    v_mov_b32 v160, 0
    v_mov_b32 v161, 0
    v_mov_b32 v162, 0
    v_mov_b32 v163, 0
    v_mov_b32 v164, 0
    v_mov_b32 v165, 0
    v_mov_b32 v166, 0
    v_mov_b32 v167, 0
    v_mov_b32 v168, 0
    v_mov_b32 v169, 0
    v_mov_b32 v170, 0
    v_mov_b32 v171, 0
    v_mov_b32 v172, 0
    v_mov_b32 v173, 0
    v_mov_b32 v174, 0
    v_mov_b32 v175, 0
    v_mov_b32 v176, 0
    v_mov_b32 v177, 0
    v_mov_b32 v178, 0
    v_mov_b32 v179, 0
    v_mov_b32 v180, 0
    v_mov_b32 v181, 0
    v_mov_b32 v182, 0
    v_mov_b32 v183, 0
    v_mov_b32 v184, 0
    v_mov_b32 v185, 0
    v_mov_b32 v186, 0
    v_mov_b32 v187, 0
    v_mov_b32 v188, 0
    v_mov_b32 v189, 0
    v_mov_b32 v190, 0
    v_mov_b32 v191, 0
    v_mov_b32 v192, 0
    v_mov_b32 v193, 0
    v_mov_b32 v194, 0
    v_mov_b32 v195, 0
    v_mov_b32 v196, 0
    v_mov_b32 v197, 0
    v_mov_b32 v198, 0
    v_mov_b32 v199, 0
    s_mul_i32 s24, s20, 4096
    s_add_u32 s24, s24, 0
    v_lshlrev_b32 v3, 4, v2
    v_add_u32 v3, s24, v3
    v_lshrrev_b32 v4, 9, v3
    v_and_b32 v3, 511, v3
    v_and_b32 v5, 3, v4
    v_lshlrev_b32 v5, 6, v5
    v_xor_b32 v3, v3, v5
    s_mov_b32 s25, 8192
    v_mul_lo_u32 v4, v4, s25
    v_add_u32 v6, v3, v4
    s_mul_i32 s24, s20, 4096
    s_add_u32 s24, s24, 1024
    v_lshlrev_b32 v3, 4, v2
    v_add_u32 v3, s24, v3
    v_lshrrev_b32 v4, 9, v3
    v_and_b32 v3, 511, v3
    v_and_b32 v5, 3, v4
    v_lshlrev_b32 v5, 6, v5
    v_xor_b32 v3, v3, v5
    s_mov_b32 s25, 8192
    v_mul_lo_u32 v4, v4, s25
    v_add_u32 v7, v3, v4
    s_mul_i32 s24, s20, 4096
    s_add_u32 s24, s24, 2048
    v_lshlrev_b32 v3, 4, v2
    v_add_u32 v3, s24, v3
    v_lshrrev_b32 v4, 9, v3
    v_and_b32 v3, 511, v3
    v_and_b32 v5, 3, v4
    v_lshlrev_b32 v5, 6, v5
    v_xor_b32 v3, v3, v5
    s_mov_b32 s25, 8192
    v_mul_lo_u32 v4, v4, s25
    v_add_u32 v8, v3, v4
    s_mul_i32 s24, s20, 4096
    s_add_u32 s24, s24, 3072
    v_lshlrev_b32 v3, 4, v2
    v_add_u32 v3, s24, v3
    v_lshrrev_b32 v4, 9, v3
    v_and_b32 v3, 511, v3
    v_and_b32 v5, 3, v4
    v_lshlrev_b32 v5, 6, v5
    v_xor_b32 v3, v3, v5
    s_mov_b32 s25, 8192
    v_mul_lo_u32 v4, v4, s25
    v_add_u32 v9, v3, v4
    v_lshrrev_b32 v3, 5, v2
    v_lshlrev_b32 v3, 3, v3
    v_bfe_u32 v4, v2, 2, 2
    v_add_u32 v3, v3, v4
    v_lshlrev_b32 v3, 9, v3
    v_bfe_u32 v5, v2, 4, 1
    v_lshlrev_b32 v5, 5, v5
    v_add_u32 v3, v3, v5
    v_and_b32 v5, 3, v2
    v_lshl_add_u32 v3, v5, 3, v3
    s_mul_i32 s24, s28, 4
    s_add_u32 s24, s24, 0
    v_xor_b32 v5, s24, v4
    v_lshl_add_u32 v14, v5, 6, v3
    s_mul_i32 s24, s28, 4
    s_add_u32 s24, s24, 1
    v_xor_b32 v5, s24, v4
    v_lshl_add_u32 v15, v5, 6, v3
    s_mul_i32 s24, s28, 4
    s_add_u32 s24, s24, 2
    v_xor_b32 v5, s24, v4
    v_lshl_add_u32 v16, v5, 6, v3
    s_mul_i32 s24, s28, 4
    s_add_u32 s24, s24, 3
    v_xor_b32 v5, s24, v4
    v_lshl_add_u32 v17, v5, 6, v3
    s_mul_i32 s24, s20, 32
    s_add_u32 s24, s24, 0
    v_lshrrev_b32 v3, 3, v2
    v_add_u32 v3, s24, v3
    v_bfe_u32 v4, v3, 1, 3
    v_and_b32 v5, 7, v2
    v_xor_b32 v4, v4, v5
    s_mov_b32 s25, 1280
    v_mul_lo_u32 v3, v3, s25
    v_lshl_add_u32 v10, v4, 4, v3
    s_mul_i32 s24, s20, 32
    s_add_u32 s24, s24, 8
    v_lshrrev_b32 v3, 3, v2
    v_add_u32 v3, s24, v3
    v_bfe_u32 v4, v3, 1, 3
    v_and_b32 v5, 7, v2
    v_xor_b32 v4, v4, v5
    s_mov_b32 s25, 1280
    v_mul_lo_u32 v3, v3, s25
    v_lshl_add_u32 v11, v4, 4, v3
    s_mul_i32 s24, s20, 32
    s_add_u32 s24, s24, 16
    v_lshrrev_b32 v3, 3, v2
    v_add_u32 v3, s24, v3
    v_bfe_u32 v4, v3, 1, 3
    v_and_b32 v5, 7, v2
    v_xor_b32 v4, v4, v5
    s_mov_b32 s25, 1280
    v_mul_lo_u32 v3, v3, s25
    v_lshl_add_u32 v12, v4, 4, v3
    s_mul_i32 s24, s20, 32
    s_add_u32 s24, s24, 24
    v_lshrrev_b32 v3, 3, v2
    v_add_u32 v3, s24, v3
    v_bfe_u32 v4, v3, 1, 3
    v_and_b32 v5, 7, v2
    v_xor_b32 v4, v4, v5
    s_mov_b32 s25, 1280
    v_mul_lo_u32 v3, v3, s25
    v_lshl_add_u32 v13, v4, 4, v3
    s_mul_i32 s24, s29, 64
    v_and_b32 v3, 31, v2
    v_add_u32 v3, s24, v3
    v_bfe_u32 v4, v3, 1, 3
    v_lshrrev_b32 v5, 5, v2
    v_lshlrev_b32 v3, 7, v3
    v_add_u32 v18, 0, v5
    v_xor_b32 v18, v18, v4
    v_lshl_add_u32 v18, v18, 4, v3
    v_add_u32 v18, 32768, v18
    v_add_u32 v19, 2, v5
    v_xor_b32 v19, v19, v4
    v_lshl_add_u32 v19, v19, 4, v3
    v_add_u32 v19, 32768, v19
    v_add_u32 v20, 4, v5
    v_xor_b32 v20, v20, v4
    v_lshl_add_u32 v20, v20, 4, v3
    v_add_u32 v20, 32768, v20
    v_add_u32 v21, 6, v5
    v_xor_b32 v21, v21, v4
    v_lshl_add_u32 v21, v21, 4, v3
    v_add_u32 v21, 32768, v21
    s_mov_b32 s22, s48
    s_mov_b32 s23, s49
    s_mov_b32 s30, 0
    s_mov_b32 s31, 0
    s_mul_i32 s27, s20, 4096
    s_add_u32 s27, s27, s30
    s_add_u32 m0, s27, 0
    s_nop 0
    buffer_load_dwordx4 v6, s[4:7], s22 offen lds
    s_add_u32 m0, s27, 1024
    s_nop 0
    buffer_load_dwordx4 v7, s[4:7], s22 offen lds
    s_add_u32 m0, s27, 2048
    s_nop 0
    buffer_load_dwordx4 v8, s[4:7], s22 offen lds
    s_add_u32 m0, s27, 3072
    s_nop 0
    buffer_load_dwordx4 v9, s[4:7], s22 offen lds
    s_mul_i32 s27, s20, 4096
    s_add_u32 s27, s27, s30
    s_add_u32 m0, s27, 32768
    s_nop 0
    buffer_load_dwordx4 v10, s[8:11], s23 offen lds
    s_add_u32 m0, s27, 33792
    s_nop 0
    buffer_load_dwordx4 v11, s[8:11], s23 offen lds
    s_add_u32 m0, s27, 34816
    s_nop 0
    buffer_load_dwordx4 v12, s[8:11], s23 offen lds
    s_add_u32 m0, s27, 35840
    s_nop 0
    buffer_load_dwordx4 v13, s[8:11], s23 offen lds
    s_add_u32 s22, s22, 524288
    s_add_u32 s23, s23, 128
    s_add_u32 s30, s30, 65536
    s_cmp_eq_u32 s30, 131072
    s_cselect_b32 s30, 0, s30
    s_mov_b32 s21, 9
p1_q_s1_loop:
    s_waitcnt vmcnt(0)
    s_barrier
    ds_read_b64_tr_b16 v[24:25], v14 offset:0
    ds_read_b64_tr_b16 v[26:27], v14 offset:2048
    ds_read_b64_tr_b16 v[28:29], v15 offset:0
    ds_read_b64_tr_b16 v[30:31], v15 offset:2048
    ds_read_b64_tr_b16 v[32:33], v16 offset:0
    ds_read_b64_tr_b16 v[34:35], v16 offset:2048
    ds_read_b64_tr_b16 v[36:37], v17 offset:0
    ds_read_b64_tr_b16 v[38:39], v17 offset:2048
    ds_read_b128 v[56:59], v18 offset:0
    ds_read_b128 v[60:63], v18 offset:4096
    ds_read_b64_tr_b16 v[40:41], v14 offset:8192
    ds_read_b64_tr_b16 v[42:43], v14 offset:10240
    ds_read_b64_tr_b16 v[44:45], v15 offset:8192
    ds_read_b64_tr_b16 v[46:47], v15 offset:10240
    ds_read_b64_tr_b16 v[48:49], v16 offset:8192
    ds_read_b64_tr_b16 v[50:51], v16 offset:10240
    ds_read_b64_tr_b16 v[52:53], v17 offset:8192
    ds_read_b64_tr_b16 v[54:55], v17 offset:10240
    ds_read_b128 v[64:67], v19 offset:0
    ds_read_b128 v[68:71], v19 offset:4096
    s_waitcnt lgkmcnt(10)
    v_mfma_f32_32x32x16_bf16 v[72:87], v[24:27], v[56:59], v[72:87]
    v_mfma_f32_32x32x16_bf16 v[88:103], v[24:27], v[60:63], v[88:103]
    s_mul_i32 s27, s20, 4096
    s_add_u32 s27, s27, s30
    s_add_u32 m0, s27, 0
    s_nop 0
    buffer_load_dwordx4 v6, s[4:7], s22 offen lds
    v_mfma_f32_32x32x16_bf16 v[104:119], v[28:31], v[56:59], v[104:119]
    v_mfma_f32_32x32x16_bf16 v[120:135], v[28:31], v[60:63], v[120:135]
    s_add_u32 m0, s27, 1024
    s_nop 0
    buffer_load_dwordx4 v7, s[4:7], s22 offen lds
    v_mfma_f32_32x32x16_bf16 v[136:151], v[32:35], v[56:59], v[136:151]
    v_mfma_f32_32x32x16_bf16 v[152:167], v[32:35], v[60:63], v[152:167]
    s_add_u32 m0, s27, 2048
    s_nop 0
    buffer_load_dwordx4 v8, s[4:7], s22 offen lds
    v_mfma_f32_32x32x16_bf16 v[168:183], v[36:39], v[56:59], v[168:183]
    v_mfma_f32_32x32x16_bf16 v[184:199], v[36:39], v[60:63], v[184:199]
    ds_read_b64_tr_b16 v[24:25], v14 offset:16384
    ds_read_b64_tr_b16 v[26:27], v14 offset:18432
    ds_read_b64_tr_b16 v[28:29], v15 offset:16384
    ds_read_b64_tr_b16 v[30:31], v15 offset:18432
    ds_read_b64_tr_b16 v[32:33], v16 offset:16384
    ds_read_b64_tr_b16 v[34:35], v16 offset:18432
    ds_read_b64_tr_b16 v[36:37], v17 offset:16384
    ds_read_b64_tr_b16 v[38:39], v17 offset:18432
    ds_read_b128 v[56:59], v20 offset:0
    ds_read_b128 v[60:63], v20 offset:4096
    s_waitcnt lgkmcnt(10)
    v_mfma_f32_32x32x16_bf16 v[72:87], v[40:43], v[64:67], v[72:87]
    v_mfma_f32_32x32x16_bf16 v[88:103], v[40:43], v[68:71], v[88:103]
    s_add_u32 m0, s27, 3072
    s_nop 0
    buffer_load_dwordx4 v9, s[4:7], s22 offen lds
    v_mfma_f32_32x32x16_bf16 v[104:119], v[44:47], v[64:67], v[104:119]
    v_mfma_f32_32x32x16_bf16 v[120:135], v[44:47], v[68:71], v[120:135]
    s_mul_i32 s27, s20, 4096
    s_add_u32 s27, s27, s30
    s_add_u32 m0, s27, 32768
    s_nop 0
    buffer_load_dwordx4 v10, s[8:11], s23 offen lds
    v_mfma_f32_32x32x16_bf16 v[136:151], v[48:51], v[64:67], v[136:151]
    v_mfma_f32_32x32x16_bf16 v[152:167], v[48:51], v[68:71], v[152:167]
    s_add_u32 m0, s27, 33792
    s_nop 0
    buffer_load_dwordx4 v11, s[8:11], s23 offen lds
    v_mfma_f32_32x32x16_bf16 v[168:183], v[52:55], v[64:67], v[168:183]
    v_mfma_f32_32x32x16_bf16 v[184:199], v[52:55], v[68:71], v[184:199]
    ds_read_b64_tr_b16 v[40:41], v14 offset:24576
    ds_read_b64_tr_b16 v[42:43], v14 offset:26624
    ds_read_b64_tr_b16 v[44:45], v15 offset:24576
    ds_read_b64_tr_b16 v[46:47], v15 offset:26624
    ds_read_b64_tr_b16 v[48:49], v16 offset:24576
    ds_read_b64_tr_b16 v[50:51], v16 offset:26624
    ds_read_b64_tr_b16 v[52:53], v17 offset:24576
    ds_read_b64_tr_b16 v[54:55], v17 offset:26624
    ds_read_b128 v[64:67], v21 offset:0
    ds_read_b128 v[68:71], v21 offset:4096
    s_waitcnt lgkmcnt(10)
    v_mfma_f32_32x32x16_bf16 v[72:87], v[24:27], v[56:59], v[72:87]
    v_mfma_f32_32x32x16_bf16 v[88:103], v[24:27], v[60:63], v[88:103]
    s_add_u32 m0, s27, 34816
    s_nop 0
    buffer_load_dwordx4 v12, s[8:11], s23 offen lds
    v_mfma_f32_32x32x16_bf16 v[104:119], v[28:31], v[56:59], v[104:119]
    v_mfma_f32_32x32x16_bf16 v[120:135], v[28:31], v[60:63], v[120:135]
    s_add_u32 m0, s27, 35840
    s_nop 0
    buffer_load_dwordx4 v13, s[8:11], s23 offen lds
    s_add_u32 s22, s22, 524288
    s_add_u32 s23, s23, 128
    s_add_u32 s30, s30, 65536
    s_cmp_eq_u32 s30, 131072
    s_cselect_b32 s30, 0, s30
    v_mfma_f32_32x32x16_bf16 v[136:151], v[32:35], v[56:59], v[136:151]
    v_mfma_f32_32x32x16_bf16 v[152:167], v[32:35], v[60:63], v[152:167]
    v_mfma_f32_32x32x16_bf16 v[168:183], v[36:39], v[56:59], v[168:183]
    v_mfma_f32_32x32x16_bf16 v[184:199], v[36:39], v[60:63], v[184:199]
    s_waitcnt lgkmcnt(0)
    v_mfma_f32_32x32x16_bf16 v[72:87], v[40:43], v[64:67], v[72:87]
    v_mfma_f32_32x32x16_bf16 v[88:103], v[40:43], v[68:71], v[88:103]
    v_mfma_f32_32x32x16_bf16 v[104:119], v[44:47], v[64:67], v[104:119]
    v_mfma_f32_32x32x16_bf16 v[120:135], v[44:47], v[68:71], v[120:135]
    v_mfma_f32_32x32x16_bf16 v[136:151], v[48:51], v[64:67], v[136:151]
    v_mfma_f32_32x32x16_bf16 v[152:167], v[48:51], v[68:71], v[152:167]
    v_mfma_f32_32x32x16_bf16 v[168:183], v[52:55], v[64:67], v[168:183]
    v_mfma_f32_32x32x16_bf16 v[184:199], v[52:55], v[68:71], v[184:199]
    s_add_u32 s24, s31, 65536
    s_cmp_eq_u32 s24, 131072
    s_cselect_b32 s24, 0, s24
    s_sub_u32 s25, s24, s31
    s_mov_b32 s31, s24
    v_add_u32 v14, s25, v14
    v_add_u32 v15, s25, v15
    v_add_u32 v16, s25, v16
    v_add_u32 v17, s25, v17
    v_add_u32 v18, s25, v18
    v_add_u32 v19, s25, v19
    v_add_u32 v20, s25, v20
    v_add_u32 v21, s25, v21
    s_sub_u32 s21, s21, 1
    s_cmp_lg_u32 s21, 0
    s_cbranch_scc1 p1_q_s1_loop
    s_waitcnt vmcnt(0)
    s_barrier
    ds_read_b64_tr_b16 v[24:25], v14 offset:0
    ds_read_b64_tr_b16 v[26:27], v14 offset:2048
    ds_read_b64_tr_b16 v[28:29], v15 offset:0
    ds_read_b64_tr_b16 v[30:31], v15 offset:2048
    ds_read_b64_tr_b16 v[32:33], v16 offset:0
    ds_read_b64_tr_b16 v[34:35], v16 offset:2048
    ds_read_b64_tr_b16 v[36:37], v17 offset:0
    ds_read_b64_tr_b16 v[38:39], v17 offset:2048
    ds_read_b128 v[56:59], v18 offset:0
    ds_read_b128 v[60:63], v18 offset:4096
    ds_read_b64_tr_b16 v[40:41], v14 offset:8192
    ds_read_b64_tr_b16 v[42:43], v14 offset:10240
    ds_read_b64_tr_b16 v[44:45], v15 offset:8192
    ds_read_b64_tr_b16 v[46:47], v15 offset:10240
    ds_read_b64_tr_b16 v[48:49], v16 offset:8192
    ds_read_b64_tr_b16 v[50:51], v16 offset:10240
    ds_read_b64_tr_b16 v[52:53], v17 offset:8192
    ds_read_b64_tr_b16 v[54:55], v17 offset:10240
    ds_read_b128 v[64:67], v19 offset:0
    ds_read_b128 v[68:71], v19 offset:4096
    s_waitcnt lgkmcnt(10)
    v_mfma_f32_32x32x16_bf16 v[72:87], v[24:27], v[56:59], v[72:87]
    v_mfma_f32_32x32x16_bf16 v[88:103], v[24:27], v[60:63], v[88:103]
    v_mfma_f32_32x32x16_bf16 v[104:119], v[28:31], v[56:59], v[104:119]
    v_mfma_f32_32x32x16_bf16 v[120:135], v[28:31], v[60:63], v[120:135]
    v_mfma_f32_32x32x16_bf16 v[136:151], v[32:35], v[56:59], v[136:151]
    v_mfma_f32_32x32x16_bf16 v[152:167], v[32:35], v[60:63], v[152:167]
    v_mfma_f32_32x32x16_bf16 v[168:183], v[36:39], v[56:59], v[168:183]
    v_mfma_f32_32x32x16_bf16 v[184:199], v[36:39], v[60:63], v[184:199]
    ds_read_b64_tr_b16 v[24:25], v14 offset:16384
    ds_read_b64_tr_b16 v[26:27], v14 offset:18432
    ds_read_b64_tr_b16 v[28:29], v15 offset:16384
    ds_read_b64_tr_b16 v[30:31], v15 offset:18432
    ds_read_b64_tr_b16 v[32:33], v16 offset:16384
    ds_read_b64_tr_b16 v[34:35], v16 offset:18432
    ds_read_b64_tr_b16 v[36:37], v17 offset:16384
    ds_read_b64_tr_b16 v[38:39], v17 offset:18432
    ds_read_b128 v[56:59], v20 offset:0
    ds_read_b128 v[60:63], v20 offset:4096
    s_waitcnt lgkmcnt(10)
    v_mfma_f32_32x32x16_bf16 v[72:87], v[40:43], v[64:67], v[72:87]
    v_mfma_f32_32x32x16_bf16 v[88:103], v[40:43], v[68:71], v[88:103]
    v_mfma_f32_32x32x16_bf16 v[104:119], v[44:47], v[64:67], v[104:119]
    v_mfma_f32_32x32x16_bf16 v[120:135], v[44:47], v[68:71], v[120:135]
    v_mfma_f32_32x32x16_bf16 v[136:151], v[48:51], v[64:67], v[136:151]
    v_mfma_f32_32x32x16_bf16 v[152:167], v[48:51], v[68:71], v[152:167]
    v_mfma_f32_32x32x16_bf16 v[168:183], v[52:55], v[64:67], v[168:183]
    v_mfma_f32_32x32x16_bf16 v[184:199], v[52:55], v[68:71], v[184:199]
    ds_read_b64_tr_b16 v[40:41], v14 offset:24576
    ds_read_b64_tr_b16 v[42:43], v14 offset:26624
    ds_read_b64_tr_b16 v[44:45], v15 offset:24576
    ds_read_b64_tr_b16 v[46:47], v15 offset:26624
    ds_read_b64_tr_b16 v[48:49], v16 offset:24576
    ds_read_b64_tr_b16 v[50:51], v16 offset:26624
    ds_read_b64_tr_b16 v[52:53], v17 offset:24576
    ds_read_b64_tr_b16 v[54:55], v17 offset:26624
    ds_read_b128 v[64:67], v21 offset:0
    ds_read_b128 v[68:71], v21 offset:4096
    s_waitcnt lgkmcnt(10)
    v_mfma_f32_32x32x16_bf16 v[72:87], v[24:27], v[56:59], v[72:87]
    v_mfma_f32_32x32x16_bf16 v[88:103], v[24:27], v[60:63], v[88:103]
    v_mfma_f32_32x32x16_bf16 v[104:119], v[28:31], v[56:59], v[104:119]
    v_mfma_f32_32x32x16_bf16 v[120:135], v[28:31], v[60:63], v[120:135]
    v_mfma_f32_32x32x16_bf16 v[136:151], v[32:35], v[56:59], v[136:151]
    v_mfma_f32_32x32x16_bf16 v[152:167], v[32:35], v[60:63], v[152:167]
    v_mfma_f32_32x32x16_bf16 v[168:183], v[36:39], v[56:59], v[168:183]
    v_mfma_f32_32x32x16_bf16 v[184:199], v[36:39], v[60:63], v[184:199]
    s_waitcnt lgkmcnt(0)
    v_mfma_f32_32x32x16_bf16 v[72:87], v[40:43], v[64:67], v[72:87]
    v_mfma_f32_32x32x16_bf16 v[88:103], v[40:43], v[68:71], v[88:103]
    v_mfma_f32_32x32x16_bf16 v[104:119], v[44:47], v[64:67], v[104:119]
    v_mfma_f32_32x32x16_bf16 v[120:135], v[44:47], v[68:71], v[120:135]
    v_mfma_f32_32x32x16_bf16 v[136:151], v[48:51], v[64:67], v[136:151]
    v_mfma_f32_32x32x16_bf16 v[152:167], v[48:51], v[68:71], v[152:167]
    v_mfma_f32_32x32x16_bf16 v[168:183], v[52:55], v[64:67], v[168:183]
    v_mfma_f32_32x32x16_bf16 v[184:199], v[52:55], v[68:71], v[184:199]
    s_add_u32 s24, s31, 65536
    s_cmp_eq_u32 s24, 131072
    s_cselect_b32 s24, 0, s24
    s_sub_u32 s25, s24, s31
    s_mov_b32 s31, s24
    v_add_u32 v14, s25, v14
    v_add_u32 v15, s25, v15
    v_add_u32 v16, s25, v16
    v_add_u32 v17, s25, v17
    v_add_u32 v18, s25, v18
    v_add_u32 v19, s25, v19
    v_add_u32 v20, s25, v20
    v_add_u32 v21, s25, v21
    s_lshr_b32 s50, s46, 7
    s_add_u32 s50, s50, s28
    s_lshl_b32 s50, s50, 19
    s_lshl_b32 s51, s29, 6
    s_add_u32 s51, s51, s47
    s_lshl_b32 s51, s51, 8
    s_add_u32 s50, s50, s51
    v_and_b32 v3, 31, v2
    v_lshlrev_b32 v3, 8, v3
    v_add_u32 v3, s50, v3
    v_lshrrev_b32 v4, 5, v2
    v_lshl_add_u32 v4, v4, 4, v3
    s_nop 15
    s_nop 7
    s_mov_b32 s24, 0
    v_cvt_pk_bf16_f32 v24, v72, v73
    v_cvt_pk_bf16_f32 v25, v74, v75
    v_cvt_pk_bf16_f32 v26, v76, v77
    v_cvt_pk_bf16_f32 v27, v78, v79
    v_cvt_pk_bf16_f32 v28, v80, v81
    v_cvt_pk_bf16_f32 v29, v82, v83
    v_cvt_pk_bf16_f32 v30, v84, v85
    v_cvt_pk_bf16_f32 v31, v86, v87
    buffer_store_dwordx4 v[24:27], v4, s[12:15], s24 offen offset:0
    buffer_store_dwordx4 v[28:31], v4, s[12:15], s24 offen offset:32
    s_nop 1
    v_cvt_pk_bf16_f32 v32, v104, v105
    v_cvt_pk_bf16_f32 v33, v106, v107
    v_cvt_pk_bf16_f32 v34, v108, v109
    v_cvt_pk_bf16_f32 v35, v110, v111
    v_cvt_pk_bf16_f32 v36, v112, v113
    v_cvt_pk_bf16_f32 v37, v114, v115
    v_cvt_pk_bf16_f32 v38, v116, v117
    v_cvt_pk_bf16_f32 v39, v118, v119
    buffer_store_dwordx4 v[32:35], v4, s[12:15], s24 offen offset:64
    buffer_store_dwordx4 v[36:39], v4, s[12:15], s24 offen offset:96
    s_nop 1
    v_cvt_pk_bf16_f32 v24, v136, v137
    v_cvt_pk_bf16_f32 v25, v138, v139
    v_cvt_pk_bf16_f32 v26, v140, v141
    v_cvt_pk_bf16_f32 v27, v142, v143
    v_cvt_pk_bf16_f32 v28, v144, v145
    v_cvt_pk_bf16_f32 v29, v146, v147
    v_cvt_pk_bf16_f32 v30, v148, v149
    v_cvt_pk_bf16_f32 v31, v150, v151
    buffer_store_dwordx4 v[24:27], v4, s[12:15], s24 offen offset:128
    buffer_store_dwordx4 v[28:31], v4, s[12:15], s24 offen offset:160
    s_nop 1
    v_cvt_pk_bf16_f32 v32, v168, v169
    v_cvt_pk_bf16_f32 v33, v170, v171
    v_cvt_pk_bf16_f32 v34, v172, v173
    v_cvt_pk_bf16_f32 v35, v174, v175
    v_cvt_pk_bf16_f32 v36, v176, v177
    v_cvt_pk_bf16_f32 v37, v178, v179
    v_cvt_pk_bf16_f32 v38, v180, v181
    v_cvt_pk_bf16_f32 v39, v182, v183
    buffer_store_dwordx4 v[32:35], v4, s[12:15], s24 offen offset:192
    buffer_store_dwordx4 v[36:39], v4, s[12:15], s24 offen offset:224
    s_nop 1
    s_mov_b32 s24, 8192
    v_cvt_pk_bf16_f32 v24, v88, v89
    v_cvt_pk_bf16_f32 v25, v90, v91
    v_cvt_pk_bf16_f32 v26, v92, v93
    v_cvt_pk_bf16_f32 v27, v94, v95
    v_cvt_pk_bf16_f32 v28, v96, v97
    v_cvt_pk_bf16_f32 v29, v98, v99
    v_cvt_pk_bf16_f32 v30, v100, v101
    v_cvt_pk_bf16_f32 v31, v102, v103
    buffer_store_dwordx4 v[24:27], v4, s[12:15], s24 offen offset:0
    buffer_store_dwordx4 v[28:31], v4, s[12:15], s24 offen offset:32
    s_nop 1
    v_cvt_pk_bf16_f32 v32, v120, v121
    v_cvt_pk_bf16_f32 v33, v122, v123
    v_cvt_pk_bf16_f32 v34, v124, v125
    v_cvt_pk_bf16_f32 v35, v126, v127
    v_cvt_pk_bf16_f32 v36, v128, v129
    v_cvt_pk_bf16_f32 v37, v130, v131
    v_cvt_pk_bf16_f32 v38, v132, v133
    v_cvt_pk_bf16_f32 v39, v134, v135
    buffer_store_dwordx4 v[32:35], v4, s[12:15], s24 offen offset:64
    buffer_store_dwordx4 v[36:39], v4, s[12:15], s24 offen offset:96
    s_nop 1
    v_cvt_pk_bf16_f32 v24, v152, v153
    v_cvt_pk_bf16_f32 v25, v154, v155
    v_cvt_pk_bf16_f32 v26, v156, v157
    v_cvt_pk_bf16_f32 v27, v158, v159
    v_cvt_pk_bf16_f32 v28, v160, v161
    v_cvt_pk_bf16_f32 v29, v162, v163
    v_cvt_pk_bf16_f32 v30, v164, v165
    v_cvt_pk_bf16_f32 v31, v166, v167
    buffer_store_dwordx4 v[24:27], v4, s[12:15], s24 offen offset:128
    buffer_store_dwordx4 v[28:31], v4, s[12:15], s24 offen offset:160
    s_nop 1
    v_cvt_pk_bf16_f32 v32, v184, v185
    v_cvt_pk_bf16_f32 v33, v186, v187
    v_cvt_pk_bf16_f32 v34, v188, v189
    v_cvt_pk_bf16_f32 v35, v190, v191
    v_cvt_pk_bf16_f32 v36, v192, v193
    v_cvt_pk_bf16_f32 v37, v194, v195
    v_cvt_pk_bf16_f32 v38, v196, v197
    v_cvt_pk_bf16_f32 v39, v198, v199
    buffer_store_dwordx4 v[32:35], v4, s[12:15], s24 offen offset:192
    buffer_store_dwordx4 v[36:39], v4, s[12:15], s24 offen offset:224
    s_nop 1
    s_endpgm
p1_k:
    s_mov_b32 s4, s36
    s_mov_b32 s5, s37
    s_mov_b32 s6, 0x400000
    s_mov_b32 s7, 0x00020000
    s_mov_b32 s8, s32
    s_mov_b32 s9, s33
    s_mov_b32 s10, 0x200000
    s_mov_b32 s11, 0x00020000
    s_add_u32 s12, s44, 0x2000000
    s_addc_u32 s13, s45, 0
    s_mov_b32 s14, 0x1000000
    s_mov_b32 s15, 0x00020000
    s_sub_u32 s3, s2, 163
    s_and_b32 s46, s3, 15
    s_lshr_b32 s47, s3, 4
    s_lshl_b32 s46, s46, 8
    s_lshl_b32 s47, s47, 8
    s_lshl_b32 s48, s46, 1
    s_mul_i32 s49, s47, 1024
    v_and_b32 v2, 63, v0
    v_lshrrev_b32 v3, 6, v0
    s_nop 0
    v_readfirstlane_b32 s20, v3
    s_nop 3
    s_and_b32 s28, s20, 1
    s_lshr_b32 s29, s20, 1
    v_mov_b32 v72, 0
    v_mov_b32 v73, 0
    v_mov_b32 v74, 0
    v_mov_b32 v75, 0
    v_mov_b32 v76, 0
    v_mov_b32 v77, 0
    v_mov_b32 v78, 0
    v_mov_b32 v79, 0
    v_mov_b32 v80, 0
    v_mov_b32 v81, 0
    v_mov_b32 v82, 0
    v_mov_b32 v83, 0
    v_mov_b32 v84, 0
    v_mov_b32 v85, 0
    v_mov_b32 v86, 0
    v_mov_b32 v87, 0
    v_mov_b32 v88, 0
    v_mov_b32 v89, 0
    v_mov_b32 v90, 0
    v_mov_b32 v91, 0
    v_mov_b32 v92, 0
    v_mov_b32 v93, 0
    v_mov_b32 v94, 0
    v_mov_b32 v95, 0
    v_mov_b32 v96, 0
    v_mov_b32 v97, 0
    v_mov_b32 v98, 0
    v_mov_b32 v99, 0
    v_mov_b32 v100, 0
    v_mov_b32 v101, 0
    v_mov_b32 v102, 0
    v_mov_b32 v103, 0
    v_mov_b32 v104, 0
    v_mov_b32 v105, 0
    v_mov_b32 v106, 0
    v_mov_b32 v107, 0
    v_mov_b32 v108, 0
    v_mov_b32 v109, 0
    v_mov_b32 v110, 0
    v_mov_b32 v111, 0
    v_mov_b32 v112, 0
    v_mov_b32 v113, 0
    v_mov_b32 v114, 0
    v_mov_b32 v115, 0
    v_mov_b32 v116, 0
    v_mov_b32 v117, 0
    v_mov_b32 v118, 0
    v_mov_b32 v119, 0
    v_mov_b32 v120, 0
    v_mov_b32 v121, 0
    v_mov_b32 v122, 0
    v_mov_b32 v123, 0
    v_mov_b32 v124, 0
    v_mov_b32 v125, 0
    v_mov_b32 v126, 0
    v_mov_b32 v127, 0
    v_mov_b32 v128, 0
    v_mov_b32 v129, 0
    v_mov_b32 v130, 0
    v_mov_b32 v131, 0
    v_mov_b32 v132, 0
    v_mov_b32 v133, 0
    v_mov_b32 v134, 0
    v_mov_b32 v135, 0
    v_mov_b32 v136, 0
    v_mov_b32 v137, 0
    v_mov_b32 v138, 0
    v_mov_b32 v139, 0
    v_mov_b32 v140, 0
    v_mov_b32 v141, 0
    v_mov_b32 v142, 0
    v_mov_b32 v143, 0
    v_mov_b32 v144, 0
    v_mov_b32 v145, 0
    v_mov_b32 v146, 0
    v_mov_b32 v147, 0
    v_mov_b32 v148, 0
    v_mov_b32 v149, 0
    v_mov_b32 v150, 0
    v_mov_b32 v151, 0
    v_mov_b32 v152, 0
    v_mov_b32 v153, 0
    v_mov_b32 v154, 0
    v_mov_b32 v155, 0
    v_mov_b32 v156, 0
    v_mov_b32 v157, 0
    v_mov_b32 v158, 0
    v_mov_b32 v159, 0
    v_mov_b32 v160, 0
    v_mov_b32 v161, 0
    v_mov_b32 v162, 0
    v_mov_b32 v163, 0
    v_mov_b32 v164, 0
    v_mov_b32 v165, 0
    v_mov_b32 v166, 0
    v_mov_b32 v167, 0
    v_mov_b32 v168, 0
    v_mov_b32 v169, 0
    v_mov_b32 v170, 0
    v_mov_b32 v171, 0
    v_mov_b32 v172, 0
    v_mov_b32 v173, 0
    v_mov_b32 v174, 0
    v_mov_b32 v175, 0
    v_mov_b32 v176, 0
    v_mov_b32 v177, 0
    v_mov_b32 v178, 0
    v_mov_b32 v179, 0
    v_mov_b32 v180, 0
    v_mov_b32 v181, 0
    v_mov_b32 v182, 0
    v_mov_b32 v183, 0
    v_mov_b32 v184, 0
    v_mov_b32 v185, 0
    v_mov_b32 v186, 0
    v_mov_b32 v187, 0
    v_mov_b32 v188, 0
    v_mov_b32 v189, 0
    v_mov_b32 v190, 0
    v_mov_b32 v191, 0
    v_mov_b32 v192, 0
    v_mov_b32 v193, 0
    v_mov_b32 v194, 0
    v_mov_b32 v195, 0
    v_mov_b32 v196, 0
    v_mov_b32 v197, 0
    v_mov_b32 v198, 0
    v_mov_b32 v199, 0
    s_mul_i32 s24, s20, 4096
    s_add_u32 s24, s24, 0
    v_lshlrev_b32 v3, 4, v2
    v_add_u32 v3, s24, v3
    v_lshrrev_b32 v4, 9, v3
    v_and_b32 v3, 511, v3
    v_and_b32 v5, 3, v4
    v_lshlrev_b32 v5, 6, v5
    v_xor_b32 v3, v3, v5
    s_mov_b32 s25, 8192
    v_mul_lo_u32 v4, v4, s25
    v_add_u32 v6, v3, v4
    s_mul_i32 s24, s20, 4096
    s_add_u32 s24, s24, 1024
    v_lshlrev_b32 v3, 4, v2
    v_add_u32 v3, s24, v3
    v_lshrrev_b32 v4, 9, v3
    v_and_b32 v3, 511, v3
    v_and_b32 v5, 3, v4
    v_lshlrev_b32 v5, 6, v5
    v_xor_b32 v3, v3, v5
    s_mov_b32 s25, 8192
    v_mul_lo_u32 v4, v4, s25
    v_add_u32 v7, v3, v4
    s_mul_i32 s24, s20, 4096
    s_add_u32 s24, s24, 2048
    v_lshlrev_b32 v3, 4, v2
    v_add_u32 v3, s24, v3
    v_lshrrev_b32 v4, 9, v3
    v_and_b32 v3, 511, v3
    v_and_b32 v5, 3, v4
    v_lshlrev_b32 v5, 6, v5
    v_xor_b32 v3, v3, v5
    s_mov_b32 s25, 8192
    v_mul_lo_u32 v4, v4, s25
    v_add_u32 v8, v3, v4
    s_mul_i32 s24, s20, 4096
    s_add_u32 s24, s24, 3072
    v_lshlrev_b32 v3, 4, v2
    v_add_u32 v3, s24, v3
    v_lshrrev_b32 v4, 9, v3
    v_and_b32 v3, 511, v3
    v_and_b32 v5, 3, v4
    v_lshlrev_b32 v5, 6, v5
    v_xor_b32 v3, v3, v5
    s_mov_b32 s25, 8192
    v_mul_lo_u32 v4, v4, s25
    v_add_u32 v9, v3, v4
    v_lshrrev_b32 v3, 5, v2
    v_lshlrev_b32 v3, 3, v3
    v_bfe_u32 v4, v2, 2, 2
    v_add_u32 v3, v3, v4
    v_lshlrev_b32 v3, 9, v3
    v_bfe_u32 v5, v2, 4, 1
    v_lshlrev_b32 v5, 5, v5
    v_add_u32 v3, v3, v5
    v_and_b32 v5, 3, v2
    v_lshl_add_u32 v3, v5, 3, v3
    s_mul_i32 s24, s28, 4
    s_add_u32 s24, s24, 0
    v_xor_b32 v5, s24, v4
    v_lshl_add_u32 v14, v5, 6, v3
    s_mul_i32 s24, s28, 4
    s_add_u32 s24, s24, 1
    v_xor_b32 v5, s24, v4
    v_lshl_add_u32 v15, v5, 6, v3
    s_mul_i32 s24, s28, 4
    s_add_u32 s24, s24, 2
    v_xor_b32 v5, s24, v4
    v_lshl_add_u32 v16, v5, 6, v3
    s_mul_i32 s24, s28, 4
    s_add_u32 s24, s24, 3
    v_xor_b32 v5, s24, v4
    v_lshl_add_u32 v17, v5, 6, v3
    s_mul_i32 s24, s20, 32
    s_add_u32 s24, s24, 0
    v_lshrrev_b32 v3, 3, v2
    v_add_u32 v3, s24, v3
    v_bfe_u32 v4, v3, 1, 3
    v_and_b32 v5, 7, v2
    v_xor_b32 v4, v4, v5
    s_mov_b32 s25, 1024
    v_mul_lo_u32 v3, v3, s25
    v_lshl_add_u32 v10, v4, 4, v3
    s_mul_i32 s24, s20, 32
    s_add_u32 s24, s24, 8
    v_lshrrev_b32 v3, 3, v2
    v_add_u32 v3, s24, v3
    v_bfe_u32 v4, v3, 1, 3
    v_and_b32 v5, 7, v2
    v_xor_b32 v4, v4, v5
    s_mov_b32 s25, 1024
    v_mul_lo_u32 v3, v3, s25
    v_lshl_add_u32 v11, v4, 4, v3
    s_mul_i32 s24, s20, 32
    s_add_u32 s24, s24, 16
    v_lshrrev_b32 v3, 3, v2
    v_add_u32 v3, s24, v3
    v_bfe_u32 v4, v3, 1, 3
    v_and_b32 v5, 7, v2
    v_xor_b32 v4, v4, v5
    s_mov_b32 s25, 1024
    v_mul_lo_u32 v3, v3, s25
    v_lshl_add_u32 v12, v4, 4, v3
    s_mul_i32 s24, s20, 32
    s_add_u32 s24, s24, 24
    v_lshrrev_b32 v3, 3, v2
    v_add_u32 v3, s24, v3
    v_bfe_u32 v4, v3, 1, 3
    v_and_b32 v5, 7, v2
    v_xor_b32 v4, v4, v5
    s_mov_b32 s25, 1024
    v_mul_lo_u32 v3, v3, s25
    v_lshl_add_u32 v13, v4, 4, v3
    s_mul_i32 s24, s29, 64
    v_and_b32 v3, 31, v2
    v_add_u32 v3, s24, v3
    v_bfe_u32 v4, v3, 1, 3
    v_lshrrev_b32 v5, 5, v2
    v_lshlrev_b32 v3, 7, v3
    v_add_u32 v18, 0, v5
    v_xor_b32 v18, v18, v4
    v_lshl_add_u32 v18, v18, 4, v3
    v_add_u32 v18, 32768, v18
    v_add_u32 v19, 2, v5
    v_xor_b32 v19, v19, v4
    v_lshl_add_u32 v19, v19, 4, v3
    v_add_u32 v19, 32768, v19
    v_add_u32 v20, 4, v5
    v_xor_b32 v20, v20, v4
    v_lshl_add_u32 v20, v20, 4, v3
    v_add_u32 v20, 32768, v20
    v_add_u32 v21, 6, v5
    v_xor_b32 v21, v21, v4
    v_lshl_add_u32 v21, v21, 4, v3
    v_add_u32 v21, 32768, v21
    s_mov_b32 s22, s48
    s_mov_b32 s23, s49
    s_mov_b32 s30, 0
    s_mov_b32 s31, 0
    s_mul_i32 s27, s20, 4096
    s_add_u32 s27, s27, s30
    s_add_u32 m0, s27, 0
    s_nop 0
    buffer_load_dwordx4 v6, s[4:7], s22 offen lds
    s_add_u32 m0, s27, 1024
    s_nop 0
    buffer_load_dwordx4 v7, s[4:7], s22 offen lds
    s_add_u32 m0, s27, 2048
    s_nop 0
    buffer_load_dwordx4 v8, s[4:7], s22 offen lds
    s_add_u32 m0, s27, 3072
    s_nop 0
    buffer_load_dwordx4 v9, s[4:7], s22 offen lds
    s_mul_i32 s27, s20, 4096
    s_add_u32 s27, s27, s30
    s_add_u32 m0, s27, 32768
    s_nop 0
    buffer_load_dwordx4 v10, s[8:11], s23 offen lds
    s_add_u32 m0, s27, 33792
    s_nop 0
    buffer_load_dwordx4 v11, s[8:11], s23 offen lds
    s_add_u32 m0, s27, 34816
    s_nop 0
    buffer_load_dwordx4 v12, s[8:11], s23 offen lds
    s_add_u32 m0, s27, 35840
    s_nop 0
    buffer_load_dwordx4 v13, s[8:11], s23 offen lds
    s_add_u32 s22, s22, 524288
    s_add_u32 s23, s23, 128
    s_add_u32 s30, s30, 65536
    s_cmp_eq_u32 s30, 131072
    s_cselect_b32 s30, 0, s30
    s_mov_b32 s21, 7
p1_k_s1_loop:
    s_waitcnt vmcnt(0)
    s_barrier
    ds_read_b64_tr_b16 v[24:25], v14 offset:0
    ds_read_b64_tr_b16 v[26:27], v14 offset:2048
    ds_read_b64_tr_b16 v[28:29], v15 offset:0
    ds_read_b64_tr_b16 v[30:31], v15 offset:2048
    ds_read_b64_tr_b16 v[32:33], v16 offset:0
    ds_read_b64_tr_b16 v[34:35], v16 offset:2048
    ds_read_b64_tr_b16 v[36:37], v17 offset:0
    ds_read_b64_tr_b16 v[38:39], v17 offset:2048
    ds_read_b128 v[56:59], v18 offset:0
    ds_read_b128 v[60:63], v18 offset:4096
    ds_read_b64_tr_b16 v[40:41], v14 offset:8192
    ds_read_b64_tr_b16 v[42:43], v14 offset:10240
    ds_read_b64_tr_b16 v[44:45], v15 offset:8192
    ds_read_b64_tr_b16 v[46:47], v15 offset:10240
    ds_read_b64_tr_b16 v[48:49], v16 offset:8192
    ds_read_b64_tr_b16 v[50:51], v16 offset:10240
    ds_read_b64_tr_b16 v[52:53], v17 offset:8192
    ds_read_b64_tr_b16 v[54:55], v17 offset:10240
    ds_read_b128 v[64:67], v19 offset:0
    ds_read_b128 v[68:71], v19 offset:4096
    s_waitcnt lgkmcnt(10)
    v_mfma_f32_32x32x16_bf16 v[72:87], v[24:27], v[56:59], v[72:87]
    v_mfma_f32_32x32x16_bf16 v[88:103], v[24:27], v[60:63], v[88:103]
    s_mul_i32 s27, s20, 4096
    s_add_u32 s27, s27, s30
    s_add_u32 m0, s27, 0
    s_nop 0
    buffer_load_dwordx4 v6, s[4:7], s22 offen lds
    v_mfma_f32_32x32x16_bf16 v[104:119], v[28:31], v[56:59], v[104:119]
    v_mfma_f32_32x32x16_bf16 v[120:135], v[28:31], v[60:63], v[120:135]
    s_add_u32 m0, s27, 1024
    s_nop 0
    buffer_load_dwordx4 v7, s[4:7], s22 offen lds
    v_mfma_f32_32x32x16_bf16 v[136:151], v[32:35], v[56:59], v[136:151]
    v_mfma_f32_32x32x16_bf16 v[152:167], v[32:35], v[60:63], v[152:167]
    s_add_u32 m0, s27, 2048
    s_nop 0
    buffer_load_dwordx4 v8, s[4:7], s22 offen lds
    v_mfma_f32_32x32x16_bf16 v[168:183], v[36:39], v[56:59], v[168:183]
    v_mfma_f32_32x32x16_bf16 v[184:199], v[36:39], v[60:63], v[184:199]
    ds_read_b64_tr_b16 v[24:25], v14 offset:16384
    ds_read_b64_tr_b16 v[26:27], v14 offset:18432
    ds_read_b64_tr_b16 v[28:29], v15 offset:16384
    ds_read_b64_tr_b16 v[30:31], v15 offset:18432
    ds_read_b64_tr_b16 v[32:33], v16 offset:16384
    ds_read_b64_tr_b16 v[34:35], v16 offset:18432
    ds_read_b64_tr_b16 v[36:37], v17 offset:16384
    ds_read_b64_tr_b16 v[38:39], v17 offset:18432
    ds_read_b128 v[56:59], v20 offset:0
    ds_read_b128 v[60:63], v20 offset:4096
    s_waitcnt lgkmcnt(10)
    v_mfma_f32_32x32x16_bf16 v[72:87], v[40:43], v[64:67], v[72:87]
    v_mfma_f32_32x32x16_bf16 v[88:103], v[40:43], v[68:71], v[88:103]
    s_add_u32 m0, s27, 3072
    s_nop 0
    buffer_load_dwordx4 v9, s[4:7], s22 offen lds
    v_mfma_f32_32x32x16_bf16 v[104:119], v[44:47], v[64:67], v[104:119]
    v_mfma_f32_32x32x16_bf16 v[120:135], v[44:47], v[68:71], v[120:135]
    s_mul_i32 s27, s20, 4096
    s_add_u32 s27, s27, s30
    s_add_u32 m0, s27, 32768
    s_nop 0
    buffer_load_dwordx4 v10, s[8:11], s23 offen lds
    v_mfma_f32_32x32x16_bf16 v[136:151], v[48:51], v[64:67], v[136:151]
    v_mfma_f32_32x32x16_bf16 v[152:167], v[48:51], v[68:71], v[152:167]
    s_add_u32 m0, s27, 33792
    s_nop 0
    buffer_load_dwordx4 v11, s[8:11], s23 offen lds
    v_mfma_f32_32x32x16_bf16 v[168:183], v[52:55], v[64:67], v[168:183]
    v_mfma_f32_32x32x16_bf16 v[184:199], v[52:55], v[68:71], v[184:199]
    ds_read_b64_tr_b16 v[40:41], v14 offset:24576
    ds_read_b64_tr_b16 v[42:43], v14 offset:26624
    ds_read_b64_tr_b16 v[44:45], v15 offset:24576
    ds_read_b64_tr_b16 v[46:47], v15 offset:26624
    ds_read_b64_tr_b16 v[48:49], v16 offset:24576
    ds_read_b64_tr_b16 v[50:51], v16 offset:26624
    ds_read_b64_tr_b16 v[52:53], v17 offset:24576
    ds_read_b64_tr_b16 v[54:55], v17 offset:26624
    ds_read_b128 v[64:67], v21 offset:0
    ds_read_b128 v[68:71], v21 offset:4096
    s_waitcnt lgkmcnt(10)
    v_mfma_f32_32x32x16_bf16 v[72:87], v[24:27], v[56:59], v[72:87]
    v_mfma_f32_32x32x16_bf16 v[88:103], v[24:27], v[60:63], v[88:103]
    s_add_u32 m0, s27, 34816
    s_nop 0
    buffer_load_dwordx4 v12, s[8:11], s23 offen lds
    v_mfma_f32_32x32x16_bf16 v[104:119], v[28:31], v[56:59], v[104:119]
    v_mfma_f32_32x32x16_bf16 v[120:135], v[28:31], v[60:63], v[120:135]
    s_add_u32 m0, s27, 35840
    s_nop 0
    buffer_load_dwordx4 v13, s[8:11], s23 offen lds
    s_add_u32 s22, s22, 524288
    s_add_u32 s23, s23, 128
    s_add_u32 s30, s30, 65536
    s_cmp_eq_u32 s30, 131072
    s_cselect_b32 s30, 0, s30
    v_mfma_f32_32x32x16_bf16 v[136:151], v[32:35], v[56:59], v[136:151]
    v_mfma_f32_32x32x16_bf16 v[152:167], v[32:35], v[60:63], v[152:167]
    v_mfma_f32_32x32x16_bf16 v[168:183], v[36:39], v[56:59], v[168:183]
    v_mfma_f32_32x32x16_bf16 v[184:199], v[36:39], v[60:63], v[184:199]
    s_waitcnt lgkmcnt(0)
    v_mfma_f32_32x32x16_bf16 v[72:87], v[40:43], v[64:67], v[72:87]
    v_mfma_f32_32x32x16_bf16 v[88:103], v[40:43], v[68:71], v[88:103]
    v_mfma_f32_32x32x16_bf16 v[104:119], v[44:47], v[64:67], v[104:119]
    v_mfma_f32_32x32x16_bf16 v[120:135], v[44:47], v[68:71], v[120:135]
    v_mfma_f32_32x32x16_bf16 v[136:151], v[48:51], v[64:67], v[136:151]
    v_mfma_f32_32x32x16_bf16 v[152:167], v[48:51], v[68:71], v[152:167]
    v_mfma_f32_32x32x16_bf16 v[168:183], v[52:55], v[64:67], v[168:183]
    v_mfma_f32_32x32x16_bf16 v[184:199], v[52:55], v[68:71], v[184:199]
    s_add_u32 s24, s31, 65536
    s_cmp_eq_u32 s24, 131072
    s_cselect_b32 s24, 0, s24
    s_sub_u32 s25, s24, s31
    s_mov_b32 s31, s24
    v_add_u32 v14, s25, v14
    v_add_u32 v15, s25, v15
    v_add_u32 v16, s25, v16
    v_add_u32 v17, s25, v17
    v_add_u32 v18, s25, v18
    v_add_u32 v19, s25, v19
    v_add_u32 v20, s25, v20
    v_add_u32 v21, s25, v21
    s_sub_u32 s21, s21, 1
    s_cmp_lg_u32 s21, 0
    s_cbranch_scc1 p1_k_s1_loop
    s_waitcnt vmcnt(0)
    s_barrier
    ds_read_b64_tr_b16 v[24:25], v14 offset:0
    ds_read_b64_tr_b16 v[26:27], v14 offset:2048
    ds_read_b64_tr_b16 v[28:29], v15 offset:0
    ds_read_b64_tr_b16 v[30:31], v15 offset:2048
    ds_read_b64_tr_b16 v[32:33], v16 offset:0
    ds_read_b64_tr_b16 v[34:35], v16 offset:2048
    ds_read_b64_tr_b16 v[36:37], v17 offset:0
    ds_read_b64_tr_b16 v[38:39], v17 offset:2048
    ds_read_b128 v[56:59], v18 offset:0
    ds_read_b128 v[60:63], v18 offset:4096
    ds_read_b64_tr_b16 v[40:41], v14 offset:8192
    ds_read_b64_tr_b16 v[42:43], v14 offset:10240
    ds_read_b64_tr_b16 v[44:45], v15 offset:8192
    ds_read_b64_tr_b16 v[46:47], v15 offset:10240
    ds_read_b64_tr_b16 v[48:49], v16 offset:8192
    ds_read_b64_tr_b16 v[50:51], v16 offset:10240
    ds_read_b64_tr_b16 v[52:53], v17 offset:8192
    ds_read_b64_tr_b16 v[54:55], v17 offset:10240
    ds_read_b128 v[64:67], v19 offset:0
    ds_read_b128 v[68:71], v19 offset:4096
    s_waitcnt lgkmcnt(10)
    v_mfma_f32_32x32x16_bf16 v[72:87], v[24:27], v[56:59], v[72:87]
    v_mfma_f32_32x32x16_bf16 v[88:103], v[24:27], v[60:63], v[88:103]
    v_mfma_f32_32x32x16_bf16 v[104:119], v[28:31], v[56:59], v[104:119]
    v_mfma_f32_32x32x16_bf16 v[120:135], v[28:31], v[60:63], v[120:135]
    v_mfma_f32_32x32x16_bf16 v[136:151], v[32:35], v[56:59], v[136:151]
    v_mfma_f32_32x32x16_bf16 v[152:167], v[32:35], v[60:63], v[152:167]
    v_mfma_f32_32x32x16_bf16 v[168:183], v[36:39], v[56:59], v[168:183]
    v_mfma_f32_32x32x16_bf16 v[184:199], v[36:39], v[60:63], v[184:199]
    ds_read_b64_tr_b16 v[24:25], v14 offset:16384
    ds_read_b64_tr_b16 v[26:27], v14 offset:18432
    ds_read_b64_tr_b16 v[28:29], v15 offset:16384
    ds_read_b64_tr_b16 v[30:31], v15 offset:18432
    ds_read_b64_tr_b16 v[32:33], v16 offset:16384
    ds_read_b64_tr_b16 v[34:35], v16 offset:18432
    ds_read_b64_tr_b16 v[36:37], v17 offset:16384
    ds_read_b64_tr_b16 v[38:39], v17 offset:18432
    ds_read_b128 v[56:59], v20 offset:0
    ds_read_b128 v[60:63], v20 offset:4096
    s_waitcnt lgkmcnt(10)
    v_mfma_f32_32x32x16_bf16 v[72:87], v[40:43], v[64:67], v[72:87]
    v_mfma_f32_32x32x16_bf16 v[88:103], v[40:43], v[68:71], v[88:103]
    v_mfma_f32_32x32x16_bf16 v[104:119], v[44:47], v[64:67], v[104:119]
    v_mfma_f32_32x32x16_bf16 v[120:135], v[44:47], v[68:71], v[120:135]
    v_mfma_f32_32x32x16_bf16 v[136:151], v[48:51], v[64:67], v[136:151]
    v_mfma_f32_32x32x16_bf16 v[152:167], v[48:51], v[68:71], v[152:167]
    v_mfma_f32_32x32x16_bf16 v[168:183], v[52:55], v[64:67], v[168:183]
    v_mfma_f32_32x32x16_bf16 v[184:199], v[52:55], v[68:71], v[184:199]
    ds_read_b64_tr_b16 v[40:41], v14 offset:24576
    ds_read_b64_tr_b16 v[42:43], v14 offset:26624
    ds_read_b64_tr_b16 v[44:45], v15 offset:24576
    ds_read_b64_tr_b16 v[46:47], v15 offset:26624
    ds_read_b64_tr_b16 v[48:49], v16 offset:24576
    ds_read_b64_tr_b16 v[50:51], v16 offset:26624
    ds_read_b64_tr_b16 v[52:53], v17 offset:24576
    ds_read_b64_tr_b16 v[54:55], v17 offset:26624
    ds_read_b128 v[64:67], v21 offset:0
    ds_read_b128 v[68:71], v21 offset:4096
    s_waitcnt lgkmcnt(10)
    v_mfma_f32_32x32x16_bf16 v[72:87], v[24:27], v[56:59], v[72:87]
    v_mfma_f32_32x32x16_bf16 v[88:103], v[24:27], v[60:63], v[88:103]
    v_mfma_f32_32x32x16_bf16 v[104:119], v[28:31], v[56:59], v[104:119]
    v_mfma_f32_32x32x16_bf16 v[120:135], v[28:31], v[60:63], v[120:135]
    v_mfma_f32_32x32x16_bf16 v[136:151], v[32:35], v[56:59], v[136:151]
    v_mfma_f32_32x32x16_bf16 v[152:167], v[32:35], v[60:63], v[152:167]
    v_mfma_f32_32x32x16_bf16 v[168:183], v[36:39], v[56:59], v[168:183]
    v_mfma_f32_32x32x16_bf16 v[184:199], v[36:39], v[60:63], v[184:199]
    s_waitcnt lgkmcnt(0)
    v_mfma_f32_32x32x16_bf16 v[72:87], v[40:43], v[64:67], v[72:87]
    v_mfma_f32_32x32x16_bf16 v[88:103], v[40:43], v[68:71], v[88:103]
    v_mfma_f32_32x32x16_bf16 v[104:119], v[44:47], v[64:67], v[104:119]
    v_mfma_f32_32x32x16_bf16 v[120:135], v[44:47], v[68:71], v[120:135]
    v_mfma_f32_32x32x16_bf16 v[136:151], v[48:51], v[64:67], v[136:151]
    v_mfma_f32_32x32x16_bf16 v[152:167], v[48:51], v[68:71], v[152:167]
    v_mfma_f32_32x32x16_bf16 v[168:183], v[52:55], v[64:67], v[168:183]
    v_mfma_f32_32x32x16_bf16 v[184:199], v[52:55], v[68:71], v[184:199]
    s_add_u32 s24, s31, 65536
    s_cmp_eq_u32 s24, 131072
    s_cselect_b32 s24, 0, s24
    s_sub_u32 s25, s24, s31
    s_mov_b32 s31, s24
    v_add_u32 v14, s25, v14
    v_add_u32 v15, s25, v15
    v_add_u32 v16, s25, v16
    v_add_u32 v17, s25, v17
    v_add_u32 v18, s25, v18
    v_add_u32 v19, s25, v19
    v_add_u32 v20, s25, v20
    v_add_u32 v21, s25, v21
    s_lshr_b32 s50, s46, 7
    s_add_u32 s50, s50, s28
    s_lshl_b32 s50, s50, 19
    s_lshl_b32 s51, s29, 6
    s_add_u32 s51, s51, s47
    s_lshl_b32 s51, s51, 8
    s_add_u32 s50, s50, s51
    v_and_b32 v3, 31, v2
    v_lshlrev_b32 v3, 8, v3
    v_add_u32 v3, s50, v3
    v_lshrrev_b32 v4, 5, v2
    v_lshl_add_u32 v4, v4, 4, v3
    s_nop 15
    s_nop 7
    s_mov_b32 s24, 0
    v_cvt_pk_bf16_f32 v24, v72, v73
    v_cvt_pk_bf16_f32 v25, v74, v75
    v_cvt_pk_bf16_f32 v26, v76, v77
    v_cvt_pk_bf16_f32 v27, v78, v79
    v_cvt_pk_bf16_f32 v28, v80, v81
    v_cvt_pk_bf16_f32 v29, v82, v83
    v_cvt_pk_bf16_f32 v30, v84, v85
    v_cvt_pk_bf16_f32 v31, v86, v87
    buffer_store_dwordx4 v[24:27], v4, s[12:15], s24 offen offset:0
    buffer_store_dwordx4 v[28:31], v4, s[12:15], s24 offen offset:32
    s_nop 1
    v_cvt_pk_bf16_f32 v32, v104, v105
    v_cvt_pk_bf16_f32 v33, v106, v107
    v_cvt_pk_bf16_f32 v34, v108, v109
    v_cvt_pk_bf16_f32 v35, v110, v111
    v_cvt_pk_bf16_f32 v36, v112, v113
    v_cvt_pk_bf16_f32 v37, v114, v115
    v_cvt_pk_bf16_f32 v38, v116, v117
    v_cvt_pk_bf16_f32 v39, v118, v119
    buffer_store_dwordx4 v[32:35], v4, s[12:15], s24 offen offset:64
    buffer_store_dwordx4 v[36:39], v4, s[12:15], s24 offen offset:96
    s_nop 1
    v_cvt_pk_bf16_f32 v24, v136, v137
    v_cvt_pk_bf16_f32 v25, v138, v139
    v_cvt_pk_bf16_f32 v26, v140, v141
    v_cvt_pk_bf16_f32 v27, v142, v143
    v_cvt_pk_bf16_f32 v28, v144, v145
    v_cvt_pk_bf16_f32 v29, v146, v147
    v_cvt_pk_bf16_f32 v30, v148, v149
    v_cvt_pk_bf16_f32 v31, v150, v151
    buffer_store_dwordx4 v[24:27], v4, s[12:15], s24 offen offset:128
    buffer_store_dwordx4 v[28:31], v4, s[12:15], s24 offen offset:160
    s_nop 1
    v_cvt_pk_bf16_f32 v32, v168, v169
    v_cvt_pk_bf16_f32 v33, v170, v171
    v_cvt_pk_bf16_f32 v34, v172, v173
    v_cvt_pk_bf16_f32 v35, v174, v175
    v_cvt_pk_bf16_f32 v36, v176, v177
    v_cvt_pk_bf16_f32 v37, v178, v179
    v_cvt_pk_bf16_f32 v38, v180, v181
    v_cvt_pk_bf16_f32 v39, v182, v183
    buffer_store_dwordx4 v[32:35], v4, s[12:15], s24 offen offset:192
    buffer_store_dwordx4 v[36:39], v4, s[12:15], s24 offen offset:224
    s_nop 1
    s_mov_b32 s24, 8192
    v_cvt_pk_bf16_f32 v24, v88, v89
    v_cvt_pk_bf16_f32 v25, v90, v91
    v_cvt_pk_bf16_f32 v26, v92, v93
    v_cvt_pk_bf16_f32 v27, v94, v95
    v_cvt_pk_bf16_f32 v28, v96, v97
    v_cvt_pk_bf16_f32 v29, v98, v99
    v_cvt_pk_bf16_f32 v30, v100, v101
    v_cvt_pk_bf16_f32 v31, v102, v103
    buffer_store_dwordx4 v[24:27], v4, s[12:15], s24 offen offset:0
    buffer_store_dwordx4 v[28:31], v4, s[12:15], s24 offen offset:32
    s_nop 1
    v_cvt_pk_bf16_f32 v32, v120, v121
    v_cvt_pk_bf16_f32 v33, v122, v123
    v_cvt_pk_bf16_f32 v34, v124, v125
    v_cvt_pk_bf16_f32 v35, v126, v127
    v_cvt_pk_bf16_f32 v36, v128, v129
    v_cvt_pk_bf16_f32 v37, v130, v131
    v_cvt_pk_bf16_f32 v38, v132, v133
    v_cvt_pk_bf16_f32 v39, v134, v135
    buffer_store_dwordx4 v[32:35], v4, s[12:15], s24 offen offset:64
    buffer_store_dwordx4 v[36:39], v4, s[12:15], s24 offen offset:96
    s_nop 1
    v_cvt_pk_bf16_f32 v24, v152, v153
    v_cvt_pk_bf16_f32 v25, v154, v155
    v_cvt_pk_bf16_f32 v26, v156, v157
    v_cvt_pk_bf16_f32 v27, v158, v159
    v_cvt_pk_bf16_f32 v28, v160, v161
    v_cvt_pk_bf16_f32 v29, v162, v163
    v_cvt_pk_bf16_f32 v30, v164, v165
    v_cvt_pk_bf16_f32 v31, v166, v167
    buffer_store_dwordx4 v[24:27], v4, s[12:15], s24 offen offset:128
    buffer_store_dwordx4 v[28:31], v4, s[12:15], s24 offen offset:160
    s_nop 1
    v_cvt_pk_bf16_f32 v32, v184, v185
    v_cvt_pk_bf16_f32 v33, v186, v187
    v_cvt_pk_bf16_f32 v34, v188, v189
    v_cvt_pk_bf16_f32 v35, v190, v191
    v_cvt_pk_bf16_f32 v36, v192, v193
    v_cvt_pk_bf16_f32 v37, v194, v195
    v_cvt_pk_bf16_f32 v38, v196, v197
    v_cvt_pk_bf16_f32 v39, v198, v199
    buffer_store_dwordx4 v[32:35], v4, s[12:15], s24 offen offset:192
    buffer_store_dwordx4 v[36:39], v4, s[12:15], s24 offen offset:224
    s_nop 1
    s_endpgm
p1_v:
    s_mov_b32 s4, s32
    s_mov_b32 s5, s33
    s_mov_b32 s6, 0x200000
    s_mov_b32 s7, 0x00020000
    s_mov_b32 s8, s38
    s_mov_b32 s9, s39
    s_mov_b32 s10, 0x400000
    s_mov_b32 s11, 0x00020000
    s_add_u32 s12, s44, 0x3000000
    s_addc_u32 s13, s45, 0
    s_mov_b32 s14, 0x1000000
    s_mov_b32 s15, 0x00020000
    s_sub_u32 s3, s2, 291
    s_and_b32 s46, s3, 7
    s_lshr_b32 s47, s3, 3
    s_lshl_b32 s46, s46, 8
    s_lshl_b32 s47, s47, 8
    s_mul_i32 s48, s46, 1024
    s_lshl_b32 s49, s47, 1
    v_and_b32 v2, 63, v0
    v_lshrrev_b32 v3, 6, v0
    s_nop 0
    v_readfirstlane_b32 s20, v3
    s_nop 3
    s_and_b32 s28, s20, 1
    s_lshr_b32 s29, s20, 1
    v_mov_b32 v72, 0
    v_mov_b32 v73, 0
    v_mov_b32 v74, 0
    v_mov_b32 v75, 0
    v_mov_b32 v76, 0
    v_mov_b32 v77, 0
    v_mov_b32 v78, 0
    v_mov_b32 v79, 0
    v_mov_b32 v80, 0
    v_mov_b32 v81, 0
    v_mov_b32 v82, 0
    v_mov_b32 v83, 0
    v_mov_b32 v84, 0
    v_mov_b32 v85, 0
    v_mov_b32 v86, 0
    v_mov_b32 v87, 0
    v_mov_b32 v88, 0
    v_mov_b32 v89, 0
    v_mov_b32 v90, 0
    v_mov_b32 v91, 0
    v_mov_b32 v92, 0
    v_mov_b32 v93, 0
    v_mov_b32 v94, 0
    v_mov_b32 v95, 0
    v_mov_b32 v96, 0
    v_mov_b32 v97, 0
    v_mov_b32 v98, 0
    v_mov_b32 v99, 0
    v_mov_b32 v100, 0
    v_mov_b32 v101, 0
    v_mov_b32 v102, 0
    v_mov_b32 v103, 0
    v_mov_b32 v104, 0
    v_mov_b32 v105, 0
    v_mov_b32 v106, 0
    v_mov_b32 v107, 0
    v_mov_b32 v108, 0
    v_mov_b32 v109, 0
    v_mov_b32 v110, 0
    v_mov_b32 v111, 0
    v_mov_b32 v112, 0
    v_mov_b32 v113, 0
    v_mov_b32 v114, 0
    v_mov_b32 v115, 0
    v_mov_b32 v116, 0
    v_mov_b32 v117, 0
    v_mov_b32 v118, 0
    v_mov_b32 v119, 0
    v_mov_b32 v120, 0
    v_mov_b32 v121, 0
    v_mov_b32 v122, 0
    v_mov_b32 v123, 0
    v_mov_b32 v124, 0
    v_mov_b32 v125, 0
    v_mov_b32 v126, 0
    v_mov_b32 v127, 0
    v_mov_b32 v128, 0
    v_mov_b32 v129, 0
    v_mov_b32 v130, 0
    v_mov_b32 v131, 0
    v_mov_b32 v132, 0
    v_mov_b32 v133, 0
    v_mov_b32 v134, 0
    v_mov_b32 v135, 0
    v_mov_b32 v136, 0
    v_mov_b32 v137, 0
    v_mov_b32 v138, 0
    v_mov_b32 v139, 0
    v_mov_b32 v140, 0
    v_mov_b32 v141, 0
    v_mov_b32 v142, 0
    v_mov_b32 v143, 0
    v_mov_b32 v144, 0
    v_mov_b32 v145, 0
    v_mov_b32 v146, 0
    v_mov_b32 v147, 0
    v_mov_b32 v148, 0
    v_mov_b32 v149, 0
    v_mov_b32 v150, 0
    v_mov_b32 v151, 0
    v_mov_b32 v152, 0
    v_mov_b32 v153, 0
    v_mov_b32 v154, 0
    v_mov_b32 v155, 0
    v_mov_b32 v156, 0
    v_mov_b32 v157, 0
    v_mov_b32 v158, 0
    v_mov_b32 v159, 0
    v_mov_b32 v160, 0
    v_mov_b32 v161, 0
    v_mov_b32 v162, 0
    v_mov_b32 v163, 0
    v_mov_b32 v164, 0
    v_mov_b32 v165, 0
    v_mov_b32 v166, 0
    v_mov_b32 v167, 0
    v_mov_b32 v168, 0
    v_mov_b32 v169, 0
    v_mov_b32 v170, 0
    v_mov_b32 v171, 0
    v_mov_b32 v172, 0
    v_mov_b32 v173, 0
    v_mov_b32 v174, 0
    v_mov_b32 v175, 0
    v_mov_b32 v176, 0
    v_mov_b32 v177, 0
    v_mov_b32 v178, 0
    v_mov_b32 v179, 0
    v_mov_b32 v180, 0
    v_mov_b32 v181, 0
    v_mov_b32 v182, 0
    v_mov_b32 v183, 0
    v_mov_b32 v184, 0
    v_mov_b32 v185, 0
    v_mov_b32 v186, 0
    v_mov_b32 v187, 0
    v_mov_b32 v188, 0
    v_mov_b32 v189, 0
    v_mov_b32 v190, 0
    v_mov_b32 v191, 0
    v_mov_b32 v192, 0
    v_mov_b32 v193, 0
    v_mov_b32 v194, 0
    v_mov_b32 v195, 0
    v_mov_b32 v196, 0
    v_mov_b32 v197, 0
    v_mov_b32 v198, 0
    v_mov_b32 v199, 0
    s_mul_i32 s24, s20, 32
    s_add_u32 s24, s24, 0
    v_lshrrev_b32 v3, 3, v2
    v_add_u32 v3, s24, v3
    v_bfe_u32 v4, v3, 1, 3
    v_and_b32 v5, 7, v2
    v_xor_b32 v4, v4, v5
    s_mov_b32 s25, 1024
    v_mul_lo_u32 v3, v3, s25
    v_lshl_add_u32 v6, v4, 4, v3
    s_mul_i32 s24, s20, 32
    s_add_u32 s24, s24, 8
    v_lshrrev_b32 v3, 3, v2
    v_add_u32 v3, s24, v3
    v_bfe_u32 v4, v3, 1, 3
    v_and_b32 v5, 7, v2
    v_xor_b32 v4, v4, v5
    s_mov_b32 s25, 1024
    v_mul_lo_u32 v3, v3, s25
    v_lshl_add_u32 v7, v4, 4, v3
    s_mul_i32 s24, s20, 32
    s_add_u32 s24, s24, 16
    v_lshrrev_b32 v3, 3, v2
    v_add_u32 v3, s24, v3
    v_bfe_u32 v4, v3, 1, 3
    v_and_b32 v5, 7, v2
    v_xor_b32 v4, v4, v5
    s_mov_b32 s25, 1024
    v_mul_lo_u32 v3, v3, s25
    v_lshl_add_u32 v8, v4, 4, v3
    s_mul_i32 s24, s20, 32
    s_add_u32 s24, s24, 24
    v_lshrrev_b32 v3, 3, v2
    v_add_u32 v3, s24, v3
    v_bfe_u32 v4, v3, 1, 3
    v_and_b32 v5, 7, v2
    v_xor_b32 v4, v4, v5
    s_mov_b32 s25, 1024
    v_mul_lo_u32 v3, v3, s25
    v_lshl_add_u32 v9, v4, 4, v3
    s_mul_i32 s24, s28, 128
    v_and_b32 v3, 31, v2
    v_add_u32 v3, s24, v3
    v_bfe_u32 v4, v3, 1, 3
    v_lshrrev_b32 v5, 5, v2
    v_lshlrev_b32 v3, 7, v3
    v_add_u32 v14, 0, v5
    v_xor_b32 v14, v14, v4
    v_lshl_add_u32 v14, v14, 4, v3
    v_add_u32 v15, 2, v5
    v_xor_b32 v15, v15, v4
    v_lshl_add_u32 v15, v15, 4, v3
    v_add_u32 v16, 4, v5
    v_xor_b32 v16, v16, v4
    v_lshl_add_u32 v16, v16, 4, v3
    v_add_u32 v17, 6, v5
    v_xor_b32 v17, v17, v4
    v_lshl_add_u32 v17, v17, 4, v3
    s_mul_i32 s24, s20, 4096
    s_add_u32 s24, s24, 0
    v_lshlrev_b32 v3, 4, v2
    v_add_u32 v3, s24, v3
    v_lshrrev_b32 v4, 9, v3
    v_and_b32 v3, 511, v3
    v_and_b32 v5, 3, v4
    v_lshlrev_b32 v5, 6, v5
    v_xor_b32 v3, v3, v5
    s_mov_b32 s25, 8192
    v_mul_lo_u32 v4, v4, s25
    v_add_u32 v10, v3, v4
    s_mul_i32 s24, s20, 4096
    s_add_u32 s24, s24, 1024
    v_lshlrev_b32 v3, 4, v2
    v_add_u32 v3, s24, v3
    v_lshrrev_b32 v4, 9, v3
    v_and_b32 v3, 511, v3
    v_and_b32 v5, 3, v4
    v_lshlrev_b32 v5, 6, v5
    v_xor_b32 v3, v3, v5
    s_mov_b32 s25, 8192
    v_mul_lo_u32 v4, v4, s25
    v_add_u32 v11, v3, v4
    s_mul_i32 s24, s20, 4096
    s_add_u32 s24, s24, 2048
    v_lshlrev_b32 v3, 4, v2
    v_add_u32 v3, s24, v3
    v_lshrrev_b32 v4, 9, v3
    v_and_b32 v3, 511, v3
    v_and_b32 v5, 3, v4
    v_lshlrev_b32 v5, 6, v5
    v_xor_b32 v3, v3, v5
    s_mov_b32 s25, 8192
    v_mul_lo_u32 v4, v4, s25
    v_add_u32 v12, v3, v4
    s_mul_i32 s24, s20, 4096
    s_add_u32 s24, s24, 3072
    v_lshlrev_b32 v3, 4, v2
    v_add_u32 v3, s24, v3
    v_lshrrev_b32 v4, 9, v3
    v_and_b32 v3, 511, v3
    v_and_b32 v5, 3, v4
    v_lshlrev_b32 v5, 6, v5
    v_xor_b32 v3, v3, v5
    s_mov_b32 s25, 8192
    v_mul_lo_u32 v4, v4, s25
    v_add_u32 v13, v3, v4
    v_lshrrev_b32 v3, 5, v2
    v_lshlrev_b32 v3, 3, v3
    v_bfe_u32 v4, v2, 2, 2
    v_add_u32 v3, v3, v4
    v_lshlrev_b32 v3, 9, v3
    v_bfe_u32 v5, v2, 4, 1
    v_lshlrev_b32 v5, 5, v5
    v_add_u32 v3, v3, v5
    v_and_b32 v5, 3, v2
    v_lshl_add_u32 v3, v5, 3, v3
    s_mul_i32 s24, s29, 2
    s_add_u32 s24, s24, 0
    v_xor_b32 v5, s24, v4
    v_lshl_add_u32 v18, v5, 6, v3
    v_add_u32 v18, 32768, v18
    s_mul_i32 s24, s29, 2
    s_add_u32 s24, s24, 1
    v_xor_b32 v5, s24, v4
    v_lshl_add_u32 v19, v5, 6, v3
    v_add_u32 v19, 32768, v19
    s_mov_b32 s22, s48
    s_mov_b32 s23, s49
    s_mov_b32 s30, 0
    s_mov_b32 s31, 0
    s_mul_i32 s27, s20, 4096
    s_add_u32 s27, s27, s30
    s_add_u32 m0, s27, 0
    s_nop 0
    buffer_load_dwordx4 v6, s[4:7], s22 offen lds
    s_add_u32 m0, s27, 1024
    s_nop 0
    buffer_load_dwordx4 v7, s[4:7], s22 offen lds
    s_add_u32 m0, s27, 2048
    s_nop 0
    buffer_load_dwordx4 v8, s[4:7], s22 offen lds
    s_add_u32 m0, s27, 3072
    s_nop 0
    buffer_load_dwordx4 v9, s[4:7], s22 offen lds
    s_mul_i32 s27, s20, 4096
    s_add_u32 s27, s27, s30
    s_add_u32 m0, s27, 32768
    s_nop 0
    buffer_load_dwordx4 v10, s[8:11], s23 offen lds
    s_add_u32 m0, s27, 33792
    s_nop 0
    buffer_load_dwordx4 v11, s[8:11], s23 offen lds
    s_add_u32 m0, s27, 34816
    s_nop 0
    buffer_load_dwordx4 v12, s[8:11], s23 offen lds
    s_add_u32 m0, s27, 35840
    s_nop 0
    buffer_load_dwordx4 v13, s[8:11], s23 offen lds
    s_add_u32 s22, s22, 128
    s_add_u32 s23, s23, 524288
    s_add_u32 s30, s30, 65536
    s_cmp_eq_u32 s30, 131072
    s_cselect_b32 s30, 0, s30
    s_mov_b32 s21, 7
p1_v_s1_loop:
    s_waitcnt vmcnt(0)
    s_barrier
    ds_read_b128 v[24:27], v14 offset:0
    ds_read_b128 v[28:31], v14 offset:4096
    ds_read_b128 v[32:35], v14 offset:8192
    ds_read_b128 v[36:39], v14 offset:12288
    ds_read_b64_tr_b16 v[56:57], v18 offset:0
    ds_read_b64_tr_b16 v[58:59], v18 offset:2048
    ds_read_b64_tr_b16 v[60:61], v19 offset:0
    ds_read_b64_tr_b16 v[62:63], v19 offset:2048
    ds_read_b128 v[40:43], v15 offset:0
    ds_read_b128 v[44:47], v15 offset:4096
    ds_read_b128 v[48:51], v15 offset:8192
    ds_read_b128 v[52:55], v15 offset:12288
    ds_read_b64_tr_b16 v[64:65], v18 offset:8192
    ds_read_b64_tr_b16 v[66:67], v18 offset:10240
    ds_read_b64_tr_b16 v[68:69], v19 offset:8192
    ds_read_b64_tr_b16 v[70:71], v19 offset:10240
    s_waitcnt lgkmcnt(8)
    v_mfma_f32_32x32x16_bf16 v[72:87], v[24:27], v[56:59], v[72:87]
    v_mfma_f32_32x32x16_bf16 v[88:103], v[24:27], v[60:63], v[88:103]
    s_mul_i32 s27, s20, 4096
    s_add_u32 s27, s27, s30
    s_add_u32 m0, s27, 0
    s_nop 0
    buffer_load_dwordx4 v6, s[4:7], s22 offen lds
    v_mfma_f32_32x32x16_bf16 v[104:119], v[28:31], v[56:59], v[104:119]
    v_mfma_f32_32x32x16_bf16 v[120:135], v[28:31], v[60:63], v[120:135]
    s_add_u32 m0, s27, 1024
    s_nop 0
    buffer_load_dwordx4 v7, s[4:7], s22 offen lds
    v_mfma_f32_32x32x16_bf16 v[136:151], v[32:35], v[56:59], v[136:151]
    v_mfma_f32_32x32x16_bf16 v[152:167], v[32:35], v[60:63], v[152:167]
    s_add_u32 m0, s27, 2048
    s_nop 0
    buffer_load_dwordx4 v8, s[4:7], s22 offen lds
    v_mfma_f32_32x32x16_bf16 v[168:183], v[36:39], v[56:59], v[168:183]
    v_mfma_f32_32x32x16_bf16 v[184:199], v[36:39], v[60:63], v[184:199]
    ds_read_b128 v[24:27], v16 offset:0
    ds_read_b128 v[28:31], v16 offset:4096
    ds_read_b128 v[32:35], v16 offset:8192
    ds_read_b128 v[36:39], v16 offset:12288
    ds_read_b64_tr_b16 v[56:57], v18 offset:16384
    ds_read_b64_tr_b16 v[58:59], v18 offset:18432
    ds_read_b64_tr_b16 v[60:61], v19 offset:16384
    ds_read_b64_tr_b16 v[62:63], v19 offset:18432
    s_waitcnt lgkmcnt(8)
    v_mfma_f32_32x32x16_bf16 v[72:87], v[40:43], v[64:67], v[72:87]
    v_mfma_f32_32x32x16_bf16 v[88:103], v[40:43], v[68:71], v[88:103]
    s_add_u32 m0, s27, 3072
    s_nop 0
    buffer_load_dwordx4 v9, s[4:7], s22 offen lds
    v_mfma_f32_32x32x16_bf16 v[104:119], v[44:47], v[64:67], v[104:119]
    v_mfma_f32_32x32x16_bf16 v[120:135], v[44:47], v[68:71], v[120:135]
    s_mul_i32 s27, s20, 4096
    s_add_u32 s27, s27, s30
    s_add_u32 m0, s27, 32768
    s_nop 0
    buffer_load_dwordx4 v10, s[8:11], s23 offen lds
    v_mfma_f32_32x32x16_bf16 v[136:151], v[48:51], v[64:67], v[136:151]
    v_mfma_f32_32x32x16_bf16 v[152:167], v[48:51], v[68:71], v[152:167]
    s_add_u32 m0, s27, 33792
    s_nop 0
    buffer_load_dwordx4 v11, s[8:11], s23 offen lds
    v_mfma_f32_32x32x16_bf16 v[168:183], v[52:55], v[64:67], v[168:183]
    v_mfma_f32_32x32x16_bf16 v[184:199], v[52:55], v[68:71], v[184:199]
    ds_read_b128 v[40:43], v17 offset:0
    ds_read_b128 v[44:47], v17 offset:4096
    ds_read_b128 v[48:51], v17 offset:8192
    ds_read_b128 v[52:55], v17 offset:12288
    ds_read_b64_tr_b16 v[64:65], v18 offset:24576
    ds_read_b64_tr_b16 v[66:67], v18 offset:26624
    ds_read_b64_tr_b16 v[68:69], v19 offset:24576
    ds_read_b64_tr_b16 v[70:71], v19 offset:26624
    s_waitcnt lgkmcnt(8)
    v_mfma_f32_32x32x16_bf16 v[72:87], v[24:27], v[56:59], v[72:87]
    v_mfma_f32_32x32x16_bf16 v[88:103], v[24:27], v[60:63], v[88:103]
    s_add_u32 m0, s27, 34816
    s_nop 0
    buffer_load_dwordx4 v12, s[8:11], s23 offen lds
    v_mfma_f32_32x32x16_bf16 v[104:119], v[28:31], v[56:59], v[104:119]
    v_mfma_f32_32x32x16_bf16 v[120:135], v[28:31], v[60:63], v[120:135]
    s_add_u32 m0, s27, 35840
    s_nop 0
    buffer_load_dwordx4 v13, s[8:11], s23 offen lds
    s_add_u32 s22, s22, 128
    s_add_u32 s23, s23, 524288
    s_add_u32 s30, s30, 65536
    s_cmp_eq_u32 s30, 131072
    s_cselect_b32 s30, 0, s30
    v_mfma_f32_32x32x16_bf16 v[136:151], v[32:35], v[56:59], v[136:151]
    v_mfma_f32_32x32x16_bf16 v[152:167], v[32:35], v[60:63], v[152:167]
    v_mfma_f32_32x32x16_bf16 v[168:183], v[36:39], v[56:59], v[168:183]
    v_mfma_f32_32x32x16_bf16 v[184:199], v[36:39], v[60:63], v[184:199]
    s_waitcnt lgkmcnt(0)
    v_mfma_f32_32x32x16_bf16 v[72:87], v[40:43], v[64:67], v[72:87]
    v_mfma_f32_32x32x16_bf16 v[88:103], v[40:43], v[68:71], v[88:103]
    v_mfma_f32_32x32x16_bf16 v[104:119], v[44:47], v[64:67], v[104:119]
    v_mfma_f32_32x32x16_bf16 v[120:135], v[44:47], v[68:71], v[120:135]
    v_mfma_f32_32x32x16_bf16 v[136:151], v[48:51], v[64:67], v[136:151]
    v_mfma_f32_32x32x16_bf16 v[152:167], v[48:51], v[68:71], v[152:167]
    v_mfma_f32_32x32x16_bf16 v[168:183], v[52:55], v[64:67], v[168:183]
    v_mfma_f32_32x32x16_bf16 v[184:199], v[52:55], v[68:71], v[184:199]
    s_add_u32 s24, s31, 65536
    s_cmp_eq_u32 s24, 131072
    s_cselect_b32 s24, 0, s24
    s_sub_u32 s25, s24, s31
    s_mov_b32 s31, s24
    v_add_u32 v14, s25, v14
    v_add_u32 v15, s25, v15
    v_add_u32 v16, s25, v16
    v_add_u32 v17, s25, v17
    v_add_u32 v18, s25, v18
    v_add_u32 v19, s25, v19
    s_sub_u32 s21, s21, 1
    s_cmp_lg_u32 s21, 0
    s_cbranch_scc1 p1_v_s1_loop
    s_waitcnt vmcnt(0)
    s_barrier
    ds_read_b128 v[24:27], v14 offset:0
    ds_read_b128 v[28:31], v14 offset:4096
    ds_read_b128 v[32:35], v14 offset:8192
    ds_read_b128 v[36:39], v14 offset:12288
    ds_read_b64_tr_b16 v[56:57], v18 offset:0
    ds_read_b64_tr_b16 v[58:59], v18 offset:2048
    ds_read_b64_tr_b16 v[60:61], v19 offset:0
    ds_read_b64_tr_b16 v[62:63], v19 offset:2048
    ds_read_b128 v[40:43], v15 offset:0
    ds_read_b128 v[44:47], v15 offset:4096
    ds_read_b128 v[48:51], v15 offset:8192
    ds_read_b128 v[52:55], v15 offset:12288
    ds_read_b64_tr_b16 v[64:65], v18 offset:8192
    ds_read_b64_tr_b16 v[66:67], v18 offset:10240
    ds_read_b64_tr_b16 v[68:69], v19 offset:8192
    ds_read_b64_tr_b16 v[70:71], v19 offset:10240
    s_waitcnt lgkmcnt(8)
    v_mfma_f32_32x32x16_bf16 v[72:87], v[24:27], v[56:59], v[72:87]
    v_mfma_f32_32x32x16_bf16 v[88:103], v[24:27], v[60:63], v[88:103]
    v_mfma_f32_32x32x16_bf16 v[104:119], v[28:31], v[56:59], v[104:119]
    v_mfma_f32_32x32x16_bf16 v[120:135], v[28:31], v[60:63], v[120:135]
    v_mfma_f32_32x32x16_bf16 v[136:151], v[32:35], v[56:59], v[136:151]
    v_mfma_f32_32x32x16_bf16 v[152:167], v[32:35], v[60:63], v[152:167]
    v_mfma_f32_32x32x16_bf16 v[168:183], v[36:39], v[56:59], v[168:183]
    v_mfma_f32_32x32x16_bf16 v[184:199], v[36:39], v[60:63], v[184:199]
    ds_read_b128 v[24:27], v16 offset:0
    ds_read_b128 v[28:31], v16 offset:4096
    ds_read_b128 v[32:35], v16 offset:8192
    ds_read_b128 v[36:39], v16 offset:12288
    ds_read_b64_tr_b16 v[56:57], v18 offset:16384
    ds_read_b64_tr_b16 v[58:59], v18 offset:18432
    ds_read_b64_tr_b16 v[60:61], v19 offset:16384
    ds_read_b64_tr_b16 v[62:63], v19 offset:18432
    s_waitcnt lgkmcnt(8)
    v_mfma_f32_32x32x16_bf16 v[72:87], v[40:43], v[64:67], v[72:87]
    v_mfma_f32_32x32x16_bf16 v[88:103], v[40:43], v[68:71], v[88:103]
    v_mfma_f32_32x32x16_bf16 v[104:119], v[44:47], v[64:67], v[104:119]
    v_mfma_f32_32x32x16_bf16 v[120:135], v[44:47], v[68:71], v[120:135]
    v_mfma_f32_32x32x16_bf16 v[136:151], v[48:51], v[64:67], v[136:151]
    v_mfma_f32_32x32x16_bf16 v[152:167], v[48:51], v[68:71], v[152:167]
    v_mfma_f32_32x32x16_bf16 v[168:183], v[52:55], v[64:67], v[168:183]
    v_mfma_f32_32x32x16_bf16 v[184:199], v[52:55], v[68:71], v[184:199]
    ds_read_b128 v[40:43], v17 offset:0
    ds_read_b128 v[44:47], v17 offset:4096
    ds_read_b128 v[48:51], v17 offset:8192
    ds_read_b128 v[52:55], v17 offset:12288
    ds_read_b64_tr_b16 v[64:65], v18 offset:24576
    ds_read_b64_tr_b16 v[66:67], v18 offset:26624
    ds_read_b64_tr_b16 v[68:69], v19 offset:24576
    ds_read_b64_tr_b16 v[70:71], v19 offset:26624
    s_waitcnt lgkmcnt(8)
    v_mfma_f32_32x32x16_bf16 v[72:87], v[24:27], v[56:59], v[72:87]
    v_mfma_f32_32x32x16_bf16 v[88:103], v[24:27], v[60:63], v[88:103]
    v_mfma_f32_32x32x16_bf16 v[104:119], v[28:31], v[56:59], v[104:119]
    v_mfma_f32_32x32x16_bf16 v[120:135], v[28:31], v[60:63], v[120:135]
    v_mfma_f32_32x32x16_bf16 v[136:151], v[32:35], v[56:59], v[136:151]
    v_mfma_f32_32x32x16_bf16 v[152:167], v[32:35], v[60:63], v[152:167]
    v_mfma_f32_32x32x16_bf16 v[168:183], v[36:39], v[56:59], v[168:183]
    v_mfma_f32_32x32x16_bf16 v[184:199], v[36:39], v[60:63], v[184:199]
    s_waitcnt lgkmcnt(0)
    v_mfma_f32_32x32x16_bf16 v[72:87], v[40:43], v[64:67], v[72:87]
    v_mfma_f32_32x32x16_bf16 v[88:103], v[40:43], v[68:71], v[88:103]
    v_mfma_f32_32x32x16_bf16 v[104:119], v[44:47], v[64:67], v[104:119]
    v_mfma_f32_32x32x16_bf16 v[120:135], v[44:47], v[68:71], v[120:135]
    v_mfma_f32_32x32x16_bf16 v[136:151], v[48:51], v[64:67], v[136:151]
    v_mfma_f32_32x32x16_bf16 v[152:167], v[48:51], v[68:71], v[152:167]
    v_mfma_f32_32x32x16_bf16 v[168:183], v[52:55], v[64:67], v[168:183]
    v_mfma_f32_32x32x16_bf16 v[184:199], v[52:55], v[68:71], v[184:199]
    s_add_u32 s24, s31, 65536
    s_cmp_eq_u32 s24, 131072
    s_cselect_b32 s24, 0, s24
    s_sub_u32 s25, s24, s31
    s_mov_b32 s31, s24
    v_add_u32 v14, s25, v14
    v_add_u32 v15, s25, v15
    v_add_u32 v16, s25, v16
    v_add_u32 v17, s25, v17
    v_add_u32 v18, s25, v18
    v_add_u32 v19, s25, v19
    s_lshr_b32 s50, s47, 7
    s_lshr_b32 s51, s29, 1
    s_add_u32 s50, s50, s51
    s_lshl_b32 s50, s50, 19
    s_lshr_b32 s51, s46, 7
    s_add_u32 s51, s51, s28
    s_lshl_b32 s51, s51, 15
    s_add_u32 s50, s50, s51
    s_and_b32 s51, s29, 1
    s_lshl_b32 s51, s51, 14
    s_add_u32 s50, s50, s51
    v_and_b32 v3, 31, v2
    v_lshlrev_b32 v3, 8, v3
    v_add_u32 v3, s50, v3
    v_lshrrev_b32 v4, 5, v2
    v_lshl_add_u32 v4, v4, 4, v3
    s_nop 15
    s_nop 7
    s_mov_b32 s24, 0
    v_cvt_pk_bf16_f32 v24, v72, v73
    v_cvt_pk_bf16_f32 v25, v74, v75
    v_cvt_pk_bf16_f32 v26, v76, v77
    v_cvt_pk_bf16_f32 v27, v78, v79
    v_cvt_pk_bf16_f32 v28, v80, v81
    v_cvt_pk_bf16_f32 v29, v82, v83
    v_cvt_pk_bf16_f32 v30, v84, v85
    v_cvt_pk_bf16_f32 v31, v86, v87
    buffer_store_dwordx4 v[24:27], v4, s[12:15], s24 offen offset:0
    buffer_store_dwordx4 v[28:31], v4, s[12:15], s24 offen offset:32
    s_nop 1
    v_cvt_pk_bf16_f32 v32, v104, v105
    v_cvt_pk_bf16_f32 v33, v106, v107
    v_cvt_pk_bf16_f32 v34, v108, v109
    v_cvt_pk_bf16_f32 v35, v110, v111
    v_cvt_pk_bf16_f32 v36, v112, v113
    v_cvt_pk_bf16_f32 v37, v114, v115
    v_cvt_pk_bf16_f32 v38, v116, v117
    v_cvt_pk_bf16_f32 v39, v118, v119
    buffer_store_dwordx4 v[32:35], v4, s[12:15], s24 offen offset:64
    buffer_store_dwordx4 v[36:39], v4, s[12:15], s24 offen offset:96
    s_nop 1
    v_cvt_pk_bf16_f32 v24, v136, v137
    v_cvt_pk_bf16_f32 v25, v138, v139
    v_cvt_pk_bf16_f32 v26, v140, v141
    v_cvt_pk_bf16_f32 v27, v142, v143
    v_cvt_pk_bf16_f32 v28, v144, v145
    v_cvt_pk_bf16_f32 v29, v146, v147
    v_cvt_pk_bf16_f32 v30, v148, v149
    v_cvt_pk_bf16_f32 v31, v150, v151
    buffer_store_dwordx4 v[24:27], v4, s[12:15], s24 offen offset:128
    buffer_store_dwordx4 v[28:31], v4, s[12:15], s24 offen offset:160
    s_nop 1
    v_cvt_pk_bf16_f32 v32, v168, v169
    v_cvt_pk_bf16_f32 v33, v170, v171
    v_cvt_pk_bf16_f32 v34, v172, v173
    v_cvt_pk_bf16_f32 v35, v174, v175
    v_cvt_pk_bf16_f32 v36, v176, v177
    v_cvt_pk_bf16_f32 v37, v178, v179
    v_cvt_pk_bf16_f32 v38, v180, v181
    v_cvt_pk_bf16_f32 v39, v182, v183
    buffer_store_dwordx4 v[32:35], v4, s[12:15], s24 offen offset:192
    buffer_store_dwordx4 v[36:39], v4, s[12:15], s24 offen offset:224
    s_nop 1
    s_mov_b32 s24, 8192
    v_cvt_pk_bf16_f32 v24, v88, v89
    v_cvt_pk_bf16_f32 v25, v90, v91
    v_cvt_pk_bf16_f32 v26, v92, v93
    v_cvt_pk_bf16_f32 v27, v94, v95
    v_cvt_pk_bf16_f32 v28, v96, v97
    v_cvt_pk_bf16_f32 v29, v98, v99
    v_cvt_pk_bf16_f32 v30, v100, v101
    v_cvt_pk_bf16_f32 v31, v102, v103
    buffer_store_dwordx4 v[24:27], v4, s[12:15], s24 offen offset:0
    buffer_store_dwordx4 v[28:31], v4, s[12:15], s24 offen offset:32
    s_nop 1
    v_cvt_pk_bf16_f32 v32, v120, v121
    v_cvt_pk_bf16_f32 v33, v122, v123
    v_cvt_pk_bf16_f32 v34, v124, v125
    v_cvt_pk_bf16_f32 v35, v126, v127
    v_cvt_pk_bf16_f32 v36, v128, v129
    v_cvt_pk_bf16_f32 v37, v130, v131
    v_cvt_pk_bf16_f32 v38, v132, v133
    v_cvt_pk_bf16_f32 v39, v134, v135
    buffer_store_dwordx4 v[32:35], v4, s[12:15], s24 offen offset:64
    buffer_store_dwordx4 v[36:39], v4, s[12:15], s24 offen offset:96
    s_nop 1
    v_cvt_pk_bf16_f32 v24, v152, v153
    v_cvt_pk_bf16_f32 v25, v154, v155
    v_cvt_pk_bf16_f32 v26, v156, v157
    v_cvt_pk_bf16_f32 v27, v158, v159
    v_cvt_pk_bf16_f32 v28, v160, v161
    v_cvt_pk_bf16_f32 v29, v162, v163
    v_cvt_pk_bf16_f32 v30, v164, v165
    v_cvt_pk_bf16_f32 v31, v166, v167
    buffer_store_dwordx4 v[24:27], v4, s[12:15], s24 offen offset:128
    buffer_store_dwordx4 v[28:31], v4, s[12:15], s24 offen offset:160
    s_nop 1
    v_cvt_pk_bf16_f32 v32, v184, v185
    v_cvt_pk_bf16_f32 v33, v186, v187
    v_cvt_pk_bf16_f32 v34, v188, v189
    v_cvt_pk_bf16_f32 v35, v190, v191
    v_cvt_pk_bf16_f32 v36, v192, v193
    v_cvt_pk_bf16_f32 v37, v194, v195
    v_cvt_pk_bf16_f32 v38, v196, v197
    v_cvt_pk_bf16_f32 v39, v198, v199
    buffer_store_dwordx4 v[32:35], v4, s[12:15], s24 offen offset:192
    buffer_store_dwordx4 v[36:39], v4, s[12:15], s24 offen offset:224
    s_nop 1
    s_endpgm
p1_u:
    s_mov_b32 s4, s40
    s_mov_b32 s5, s41
    s_mov_b32 s6, 0x6c0000
    s_mov_b32 s7, 0x00020000
    s_add_u32 s8, s44, 0x280000
    s_addc_u32 s9, s45, 0
    s_mov_b32 s10, 0x280000
    s_mov_b32 s11, 0x00020000
    s_add_u32 s12, s44, 0x4000000
    s_addc_u32 s13, s45, 0
    s_mov_b32 s14, 0x21c000
    s_mov_b32 s15, 0x00020000
    s_mov_b32 s16, s42
    s_mov_b32 s17, s43
    s_mov_b32 s18, 0xd80
    s_mov_b32 s19, 0x00020000
    s_mul_i32 s46, s2, 37
    s_lshr_b32 s47, s46, 8
    s_mul_i32 s46, s47, 7
    s_sub_u32 s46, s2, s46
    s_lshl_b32 s46, s46, 8
    s_lshl_b32 s47, s47, 7
    s_lshl_b32 s48, s46, 1
    s_lshl_b32 s49, s47, 1
    v_and_b32 v2, 63, v0
    v_lshrrev_b32 v3, 6, v0
    s_nop 0
    v_readfirstlane_b32 s20, v3
    s_nop 3
    s_and_b32 s28, s20, 3
    s_lshr_b32 s29, s20, 2
    v_mov_b32 v52, 0
    v_mov_b32 v53, 0
    v_mov_b32 v54, 0
    v_mov_b32 v55, 0
    v_mov_b32 v56, 0
    v_mov_b32 v57, 0
    v_mov_b32 v58, 0
    v_mov_b32 v59, 0
    v_mov_b32 v60, 0
    v_mov_b32 v61, 0
    v_mov_b32 v62, 0
    v_mov_b32 v63, 0
    v_mov_b32 v64, 0
    v_mov_b32 v65, 0
    v_mov_b32 v66, 0
    v_mov_b32 v67, 0
    v_mov_b32 v68, 0
    v_mov_b32 v69, 0
    v_mov_b32 v70, 0
    v_mov_b32 v71, 0
    v_mov_b32 v72, 0
    v_mov_b32 v73, 0
    v_mov_b32 v74, 0
    v_mov_b32 v75, 0
    v_mov_b32 v76, 0
    v_mov_b32 v77, 0
    v_mov_b32 v78, 0
    v_mov_b32 v79, 0
    v_mov_b32 v80, 0
    v_mov_b32 v81, 0
    v_mov_b32 v82, 0
    v_mov_b32 v83, 0
    v_mov_b32 v84, 0
    v_mov_b32 v85, 0
    v_mov_b32 v86, 0
    v_mov_b32 v87, 0
    v_mov_b32 v88, 0
    v_mov_b32 v89, 0
    v_mov_b32 v90, 0
    v_mov_b32 v91, 0
    v_mov_b32 v92, 0
    v_mov_b32 v93, 0
    v_mov_b32 v94, 0
    v_mov_b32 v95, 0
    v_mov_b32 v96, 0
    v_mov_b32 v97, 0
    v_mov_b32 v98, 0
    v_mov_b32 v99, 0
    v_mov_b32 v100, 0
    v_mov_b32 v101, 0
    v_mov_b32 v102, 0
    v_mov_b32 v103, 0
    v_mov_b32 v104, 0
    v_mov_b32 v105, 0
    v_mov_b32 v106, 0
    v_mov_b32 v107, 0
    v_mov_b32 v108, 0
    v_mov_b32 v109, 0
    v_mov_b32 v110, 0
    v_mov_b32 v111, 0
    v_mov_b32 v112, 0
    v_mov_b32 v113, 0
    v_mov_b32 v114, 0
    v_mov_b32 v115, 0
    s_mul_i32 s24, s20, 4096
    s_add_u32 s24, s24, 0
    v_lshlrev_b32 v3, 4, v2
    v_add_u32 v3, s24, v3
    v_lshrrev_b32 v4, 9, v3
    v_and_b32 v3, 511, v3
    v_and_b32 v5, 3, v4
    v_lshlrev_b32 v5, 6, v5
    v_xor_b32 v3, v3, v5
    s_mov_b32 s25, 3456
    v_mul_lo_u32 v4, v4, s25
    v_add_u32 v6, v3, v4
    s_mul_i32 s24, s20, 4096
    s_add_u32 s24, s24, 1024
    v_lshlrev_b32 v3, 4, v2
    v_add_u32 v3, s24, v3
    v_lshrrev_b32 v4, 9, v3
    v_and_b32 v3, 511, v3
    v_and_b32 v5, 3, v4
    v_lshlrev_b32 v5, 6, v5
    v_xor_b32 v3, v3, v5
    s_mov_b32 s25, 3456
    v_mul_lo_u32 v4, v4, s25
    v_add_u32 v7, v3, v4
    s_mul_i32 s24, s20, 4096
    s_add_u32 s24, s24, 2048
    v_lshlrev_b32 v3, 4, v2
    v_add_u32 v3, s24, v3
    v_lshrrev_b32 v4, 9, v3
    v_and_b32 v3, 511, v3
    v_and_b32 v5, 3, v4
    v_lshlrev_b32 v5, 6, v5
    v_xor_b32 v3, v3, v5
    s_mov_b32 s25, 3456
    v_mul_lo_u32 v4, v4, s25
    v_add_u32 v8, v3, v4
    s_mul_i32 s24, s20, 4096
    s_add_u32 s24, s24, 3072
    v_lshlrev_b32 v3, 4, v2
    v_add_u32 v3, s24, v3
    v_lshrrev_b32 v4, 9, v3
    v_and_b32 v3, 511, v3
    v_and_b32 v5, 3, v4
    v_lshlrev_b32 v5, 6, v5
    v_xor_b32 v3, v3, v5
    s_mov_b32 s25, 3456
    v_mul_lo_u32 v4, v4, s25
    v_add_u32 v9, v3, v4
    v_lshrrev_b32 v3, 5, v2
    v_lshlrev_b32 v3, 3, v3
    v_bfe_u32 v4, v2, 2, 2
    v_add_u32 v3, v3, v4
    v_lshlrev_b32 v3, 9, v3
    v_bfe_u32 v5, v2, 4, 1
    v_lshlrev_b32 v5, 5, v5
    v_add_u32 v3, v3, v5
    v_and_b32 v5, 3, v2
    v_lshl_add_u32 v3, v5, 3, v3
    s_mul_i32 s24, s28, 2
    s_add_u32 s24, s24, 0
    v_xor_b32 v5, s24, v4
    v_lshl_add_u32 v12, v5, 6, v3
    s_mul_i32 s24, s28, 2
    s_add_u32 s24, s24, 1
    v_xor_b32 v5, s24, v4
    v_lshl_add_u32 v13, v5, 6, v3
    s_mul_i32 s24, s20, 2048
    s_add_u32 s24, s24, 0
    v_lshlrev_b32 v3, 4, v2
    v_add_u32 v3, s24, v3
    v_lshrrev_b32 v4, 8, v3
    v_and_b32 v3, 255, v3
    v_and_b32 v5, 3, v4
    v_lshlrev_b32 v5, 6, v5
    v_xor_b32 v3, v3, v5
    s_mov_b32 s25, 1280
    v_mul_lo_u32 v4, v4, s25
    v_add_u32 v10, v3, v4
    s_mul_i32 s24, s20, 2048
    s_add_u32 s24, s24, 1024
    v_lshlrev_b32 v3, 4, v2
    v_add_u32 v3, s24, v3
    v_lshrrev_b32 v4, 8, v3
    v_and_b32 v3, 255, v3
    v_and_b32 v5, 3, v4
    v_lshlrev_b32 v5, 6, v5
    v_xor_b32 v3, v3, v5
    s_mov_b32 s25, 1280
    v_mul_lo_u32 v4, v4, s25
    v_add_u32 v11, v3, v4
    v_lshrrev_b32 v3, 5, v2
    v_lshlrev_b32 v3, 3, v3
    v_bfe_u32 v4, v2, 2, 2
    v_add_u32 v3, v3, v4
    v_lshlrev_b32 v3, 8, v3
    v_bfe_u32 v5, v2, 4, 1
    v_lshlrev_b32 v5, 5, v5
    v_add_u32 v3, v3, v5
    v_and_b32 v5, 3, v2
    v_lshl_add_u32 v3, v5, 3, v3
    s_mul_i32 s24, s29, 2
    s_add_u32 s24, s24, 0
    v_xor_b32 v5, s24, v4
    v_lshl_add_u32 v16, v5, 6, v3
    v_add_u32 v16, 32768, v16
    s_mul_i32 s24, s29, 2
    s_add_u32 s24, s24, 1
    v_xor_b32 v5, s24, v4
    v_lshl_add_u32 v17, v5, 6, v3
    v_add_u32 v17, 32768, v17
    s_mov_b32 s22, s48
    s_mov_b32 s23, s49
    s_mov_b32 s30, 0
    s_mov_b32 s31, 0
    s_mul_i32 s27, s20, 4096
    s_add_u32 s27, s27, s30
    s_add_u32 m0, s27, 0
    s_nop 0
    buffer_load_dwordx4 v6, s[4:7], s22 offen lds
    s_add_u32 m0, s27, 1024
    s_nop 0
    buffer_load_dwordx4 v7, s[4:7], s22 offen lds
    s_add_u32 m0, s27, 2048
    s_nop 0
    buffer_load_dwordx4 v8, s[4:7], s22 offen lds
    s_add_u32 m0, s27, 3072
    s_nop 0
    buffer_load_dwordx4 v9, s[4:7], s22 offen lds
    s_mul_i32 s27, s20, 2048
    s_add_u32 s27, s27, s30
    s_add_u32 m0, s27, 32768
    s_nop 0
    buffer_load_dwordx4 v10, s[8:11], s23 offen lds
    s_add_u32 m0, s27, 33792
    s_nop 0
    buffer_load_dwordx4 v11, s[8:11], s23 offen lds
    s_add_u32 s22, s22, 221184
    s_add_u32 s23, s23, 81920
    s_add_u32 s30, s30, 49152
    s_cmp_eq_u32 s30, 98304
    s_cselect_b32 s30, 0, s30
    s_mov_b32 s21, 31
p1_u_s1_loop:
    s_waitcnt vmcnt(0)
    s_barrier
    ds_read_b64_tr_b16 v[20:21], v12 offset:0
    ds_read_b64_tr_b16 v[22:23], v12 offset:2048
    ds_read_b64_tr_b16 v[24:25], v13 offset:0
    ds_read_b64_tr_b16 v[26:27], v13 offset:2048
    ds_read_b64_tr_b16 v[36:37], v16 offset:0
    ds_read_b64_tr_b16 v[38:39], v16 offset:1024
    ds_read_b64_tr_b16 v[40:41], v17 offset:0
    ds_read_b64_tr_b16 v[42:43], v17 offset:1024
    ds_read_b64_tr_b16 v[28:29], v12 offset:8192
    ds_read_b64_tr_b16 v[30:31], v12 offset:10240
    ds_read_b64_tr_b16 v[32:33], v13 offset:8192
    ds_read_b64_tr_b16 v[34:35], v13 offset:10240
    ds_read_b64_tr_b16 v[44:45], v16 offset:4096
    ds_read_b64_tr_b16 v[46:47], v16 offset:5120
    ds_read_b64_tr_b16 v[48:49], v17 offset:4096
    ds_read_b64_tr_b16 v[50:51], v17 offset:5120
    s_waitcnt lgkmcnt(8)
    v_mfma_f32_32x32x16_bf16 v[52:67], v[20:23], v[36:39], v[52:67]
    v_mfma_f32_32x32x16_bf16 v[68:83], v[20:23], v[40:43], v[68:83]
    s_mul_i32 s27, s20, 4096
    s_add_u32 s27, s27, s30
    s_add_u32 m0, s27, 0
    s_nop 0
    buffer_load_dwordx4 v6, s[4:7], s22 offen lds
    v_mfma_f32_32x32x16_bf16 v[84:99], v[24:27], v[36:39], v[84:99]
    v_mfma_f32_32x32x16_bf16 v[100:115], v[24:27], v[40:43], v[100:115]
    s_add_u32 m0, s27, 1024
    s_nop 0
    buffer_load_dwordx4 v7, s[4:7], s22 offen lds
    ds_read_b64_tr_b16 v[20:21], v12 offset:16384
    ds_read_b64_tr_b16 v[22:23], v12 offset:18432
    ds_read_b64_tr_b16 v[24:25], v13 offset:16384
    ds_read_b64_tr_b16 v[26:27], v13 offset:18432
    ds_read_b64_tr_b16 v[36:37], v16 offset:8192
    ds_read_b64_tr_b16 v[38:39], v16 offset:9216
    ds_read_b64_tr_b16 v[40:41], v17 offset:8192
    ds_read_b64_tr_b16 v[42:43], v17 offset:9216
    s_waitcnt lgkmcnt(8)
    v_mfma_f32_32x32x16_bf16 v[52:67], v[28:31], v[44:47], v[52:67]
    v_mfma_f32_32x32x16_bf16 v[68:83], v[28:31], v[48:51], v[68:83]
    s_add_u32 m0, s27, 2048
    s_nop 0
    buffer_load_dwordx4 v8, s[4:7], s22 offen lds
    v_mfma_f32_32x32x16_bf16 v[84:99], v[32:35], v[44:47], v[84:99]
    v_mfma_f32_32x32x16_bf16 v[100:115], v[32:35], v[48:51], v[100:115]
    s_add_u32 m0, s27, 3072
    s_nop 0
    buffer_load_dwordx4 v9, s[4:7], s22 offen lds
    ds_read_b64_tr_b16 v[28:29], v12 offset:24576
    ds_read_b64_tr_b16 v[30:31], v12 offset:26624
    ds_read_b64_tr_b16 v[32:33], v13 offset:24576
    ds_read_b64_tr_b16 v[34:35], v13 offset:26624
    ds_read_b64_tr_b16 v[44:45], v16 offset:12288
    ds_read_b64_tr_b16 v[46:47], v16 offset:13312
    ds_read_b64_tr_b16 v[48:49], v17 offset:12288
    ds_read_b64_tr_b16 v[50:51], v17 offset:13312
    s_waitcnt lgkmcnt(8)
    v_mfma_f32_32x32x16_bf16 v[52:67], v[20:23], v[36:39], v[52:67]
    v_mfma_f32_32x32x16_bf16 v[68:83], v[20:23], v[40:43], v[68:83]
    s_mul_i32 s27, s20, 2048
    s_add_u32 s27, s27, s30
    s_add_u32 m0, s27, 32768
    s_nop 0
    buffer_load_dwordx4 v10, s[8:11], s23 offen lds
    v_mfma_f32_32x32x16_bf16 v[84:99], v[24:27], v[36:39], v[84:99]
    v_mfma_f32_32x32x16_bf16 v[100:115], v[24:27], v[40:43], v[100:115]
    s_add_u32 m0, s27, 33792
    s_nop 0
    buffer_load_dwordx4 v11, s[8:11], s23 offen lds
    s_add_u32 s22, s22, 221184
    s_add_u32 s23, s23, 81920
    s_add_u32 s30, s30, 49152
    s_cmp_eq_u32 s30, 98304
    s_cselect_b32 s30, 0, s30
    s_waitcnt lgkmcnt(0)
    v_mfma_f32_32x32x16_bf16 v[52:67], v[28:31], v[44:47], v[52:67]
    v_mfma_f32_32x32x16_bf16 v[68:83], v[28:31], v[48:51], v[68:83]
    v_mfma_f32_32x32x16_bf16 v[84:99], v[32:35], v[44:47], v[84:99]
    v_mfma_f32_32x32x16_bf16 v[100:115], v[32:35], v[48:51], v[100:115]
    s_add_u32 s24, s31, 49152
    s_cmp_eq_u32 s24, 98304
    s_cselect_b32 s24, 0, s24
    s_sub_u32 s25, s24, s31
    s_mov_b32 s31, s24
    v_add_u32 v12, s25, v12
    v_add_u32 v13, s25, v13
    v_add_u32 v16, s25, v16
    v_add_u32 v17, s25, v17
    s_sub_u32 s21, s21, 1
    s_cmp_lg_u32 s21, 0
    s_cbranch_scc1 p1_u_s1_loop
    s_waitcnt vmcnt(0)
    s_barrier
    ds_read_b64_tr_b16 v[20:21], v12 offset:0
    ds_read_b64_tr_b16 v[22:23], v12 offset:2048
    ds_read_b64_tr_b16 v[24:25], v13 offset:0
    ds_read_b64_tr_b16 v[26:27], v13 offset:2048
    ds_read_b64_tr_b16 v[36:37], v16 offset:0
    ds_read_b64_tr_b16 v[38:39], v16 offset:1024
    ds_read_b64_tr_b16 v[40:41], v17 offset:0
    ds_read_b64_tr_b16 v[42:43], v17 offset:1024
    ds_read_b64_tr_b16 v[28:29], v12 offset:8192
    ds_read_b64_tr_b16 v[30:31], v12 offset:10240
    ds_read_b64_tr_b16 v[32:33], v13 offset:8192
    ds_read_b64_tr_b16 v[34:35], v13 offset:10240
    ds_read_b64_tr_b16 v[44:45], v16 offset:4096
    ds_read_b64_tr_b16 v[46:47], v16 offset:5120
    ds_read_b64_tr_b16 v[48:49], v17 offset:4096
    ds_read_b64_tr_b16 v[50:51], v17 offset:5120
    s_waitcnt lgkmcnt(8)
    v_mfma_f32_32x32x16_bf16 v[52:67], v[20:23], v[36:39], v[52:67]
    v_mfma_f32_32x32x16_bf16 v[68:83], v[20:23], v[40:43], v[68:83]
    v_mfma_f32_32x32x16_bf16 v[84:99], v[24:27], v[36:39], v[84:99]
    v_mfma_f32_32x32x16_bf16 v[100:115], v[24:27], v[40:43], v[100:115]
    ds_read_b64_tr_b16 v[20:21], v12 offset:16384
    ds_read_b64_tr_b16 v[22:23], v12 offset:18432
    ds_read_b64_tr_b16 v[24:25], v13 offset:16384
    ds_read_b64_tr_b16 v[26:27], v13 offset:18432
    ds_read_b64_tr_b16 v[36:37], v16 offset:8192
    ds_read_b64_tr_b16 v[38:39], v16 offset:9216
    ds_read_b64_tr_b16 v[40:41], v17 offset:8192
    ds_read_b64_tr_b16 v[42:43], v17 offset:9216
    s_waitcnt lgkmcnt(8)
    v_mfma_f32_32x32x16_bf16 v[52:67], v[28:31], v[44:47], v[52:67]
    v_mfma_f32_32x32x16_bf16 v[68:83], v[28:31], v[48:51], v[68:83]
    v_mfma_f32_32x32x16_bf16 v[84:99], v[32:35], v[44:47], v[84:99]
    v_mfma_f32_32x32x16_bf16 v[100:115], v[32:35], v[48:51], v[100:115]
    ds_read_b64_tr_b16 v[28:29], v12 offset:24576
    ds_read_b64_tr_b16 v[30:31], v12 offset:26624
    ds_read_b64_tr_b16 v[32:33], v13 offset:24576
    ds_read_b64_tr_b16 v[34:35], v13 offset:26624
    ds_read_b64_tr_b16 v[44:45], v16 offset:12288
    ds_read_b64_tr_b16 v[46:47], v16 offset:13312
    ds_read_b64_tr_b16 v[48:49], v17 offset:12288
    ds_read_b64_tr_b16 v[50:51], v17 offset:13312
    s_waitcnt lgkmcnt(8)
    v_mfma_f32_32x32x16_bf16 v[52:67], v[20:23], v[36:39], v[52:67]
    v_mfma_f32_32x32x16_bf16 v[68:83], v[20:23], v[40:43], v[68:83]
    v_mfma_f32_32x32x16_bf16 v[84:99], v[24:27], v[36:39], v[84:99]
    v_mfma_f32_32x32x16_bf16 v[100:115], v[24:27], v[40:43], v[100:115]
    s_waitcnt lgkmcnt(0)
    v_mfma_f32_32x32x16_bf16 v[52:67], v[28:31], v[44:47], v[52:67]
    v_mfma_f32_32x32x16_bf16 v[68:83], v[28:31], v[48:51], v[68:83]
    v_mfma_f32_32x32x16_bf16 v[84:99], v[32:35], v[44:47], v[84:99]
    v_mfma_f32_32x32x16_bf16 v[100:115], v[32:35], v[48:51], v[100:115]
    s_add_u32 s24, s31, 49152
    s_cmp_eq_u32 s24, 98304
    s_cselect_b32 s24, 0, s24
    s_sub_u32 s25, s24, s31
    s_mov_b32 s31, s24
    v_add_u32 v12, s25, v12
    v_add_u32 v13, s25, v13
    v_add_u32 v16, s25, v16
    v_add_u32 v17, s25, v17
    s_mul_i32 s24, s29, 64
    s_add_u32 s24, s24, s47
    v_and_b32 v3, 31, v2
    v_add_u32 v3, s24, v3
    s_mov_b32 s25, 3456
    v_mul_lo_u32 v3, v3, s25
    s_mul_i32 s24, s28, 64
    s_add_u32 s24, s24, s46
    s_lshl_b32 s24, s24, 1
    v_add_u32 v3, s24, v3
    v_lshrrev_b32 v4, 5, v2
    v_lshl_add_u32 v4, v4, 4, v3
    s_mul_i32 s24, s28, 64
    s_add_u32 s50, s24, s46
    s_lshl_b32 s24, s50, 1
    v_lshrrev_b32 v5, 5, v2
    v_lshlrev_b32 v5, 3, v5
    v_add_u32 v5, s24, v5
    s_nop 15
    s_nop 7
    s_mov_b32 s51, 0xffff0000
    s_mov_b32 s52, 0x3d372713
    s_mov_b32 s53, 0xc0135761
    s_add_u32 s24, s50, 0
    s_cmp_ge_u32 s24, 1728
    s_cbranch_scc1 p1_u_skip0
    buffer_load_dwordx2 v[20:21], v5, s[16:19], 0 offen offset:0
    buffer_load_dwordx2 v[22:23], v5, s[16:19], 0 offen offset:16
    buffer_load_dwordx2 v[24:25], v5, s[16:19], 0 offen offset:32
    buffer_load_dwordx2 v[26:27], v5, s[16:19], 0 offen offset:48
    s_waitcnt vmcnt(0)
    v_lshlrev_b32 v28, 16, v20
    v_and_b32 v29, s51, v20
    v_lshlrev_b32 v30, 16, v21
    v_and_b32 v31, s51, v21
    v_lshlrev_b32 v32, 16, v22
    v_and_b32 v33, s51, v22
    v_lshlrev_b32 v34, 16, v23
    v_and_b32 v35, s51, v23
    v_lshlrev_b32 v36, 16, v24
    v_and_b32 v37, s51, v24
    v_lshlrev_b32 v38, 16, v25
    v_and_b32 v39, s51, v25
    v_lshlrev_b32 v40, 16, v26
    v_and_b32 v41, s51, v26
    v_lshlrev_b32 v42, 16, v27
    v_and_b32 v43, s51, v27
    v_add_f32 v52, v52, v28
    v_mul_f32 v44, v52, v52
    v_fma_f32 v44, v44, s52, 1.0
    v_mul_f32 v44, v44, v52
    v_mul_f32 v44, s53, v44
    v_exp_f32 v44, v44
    s_nop 0
    v_add_f32 v44, 1.0, v44
    v_rcp_f32 v44, v44
    s_nop 0
    v_mul_f32 v52, v52, v44
    v_add_f32 v53, v53, v29
    v_mul_f32 v44, v53, v53
    v_fma_f32 v44, v44, s52, 1.0
    v_mul_f32 v44, v44, v53
    v_mul_f32 v44, s53, v44
    v_exp_f32 v44, v44
    s_nop 0
    v_add_f32 v44, 1.0, v44
    v_rcp_f32 v44, v44
    s_nop 0
    v_mul_f32 v53, v53, v44
    v_add_f32 v54, v54, v30
    v_mul_f32 v44, v54, v54
    v_fma_f32 v44, v44, s52, 1.0
    v_mul_f32 v44, v44, v54
    v_mul_f32 v44, s53, v44
    v_exp_f32 v44, v44
    s_nop 0
    v_add_f32 v44, 1.0, v44
    v_rcp_f32 v44, v44
    s_nop 0
    v_mul_f32 v54, v54, v44
    v_add_f32 v55, v55, v31
    v_mul_f32 v44, v55, v55
    v_fma_f32 v44, v44, s52, 1.0
    v_mul_f32 v44, v44, v55
    v_mul_f32 v44, s53, v44
    v_exp_f32 v44, v44
    s_nop 0
    v_add_f32 v44, 1.0, v44
    v_rcp_f32 v44, v44
    s_nop 0
    v_mul_f32 v55, v55, v44
    v_add_f32 v56, v56, v32
    v_mul_f32 v44, v56, v56
    v_fma_f32 v44, v44, s52, 1.0
    v_mul_f32 v44, v44, v56
    v_mul_f32 v44, s53, v44
    v_exp_f32 v44, v44
    s_nop 0
    v_add_f32 v44, 1.0, v44
    v_rcp_f32 v44, v44
    s_nop 0
    v_mul_f32 v56, v56, v44
    v_add_f32 v57, v57, v33
    v_mul_f32 v44, v57, v57
    v_fma_f32 v44, v44, s52, 1.0
    v_mul_f32 v44, v44, v57
    v_mul_f32 v44, s53, v44
    v_exp_f32 v44, v44
    s_nop 0
    v_add_f32 v44, 1.0, v44
    v_rcp_f32 v44, v44
    s_nop 0
    v_mul_f32 v57, v57, v44
    v_add_f32 v58, v58, v34
    v_mul_f32 v44, v58, v58
    v_fma_f32 v44, v44, s52, 1.0
    v_mul_f32 v44, v44, v58
    v_mul_f32 v44, s53, v44
    v_exp_f32 v44, v44
    s_nop 0
    v_add_f32 v44, 1.0, v44
    v_rcp_f32 v44, v44
    s_nop 0
    v_mul_f32 v58, v58, v44
    v_add_f32 v59, v59, v35
    v_mul_f32 v44, v59, v59
    v_fma_f32 v44, v44, s52, 1.0
    v_mul_f32 v44, v44, v59
    v_mul_f32 v44, s53, v44
    v_exp_f32 v44, v44
    s_nop 0
    v_add_f32 v44, 1.0, v44
    v_rcp_f32 v44, v44
    s_nop 0
    v_mul_f32 v59, v59, v44
    v_add_f32 v60, v60, v36
    v_mul_f32 v44, v60, v60
    v_fma_f32 v44, v44, s52, 1.0
    v_mul_f32 v44, v44, v60
    v_mul_f32 v44, s53, v44
    v_exp_f32 v44, v44
    s_nop 0
    v_add_f32 v44, 1.0, v44
    v_rcp_f32 v44, v44
    s_nop 0
    v_mul_f32 v60, v60, v44
    v_add_f32 v61, v61, v37
    v_mul_f32 v44, v61, v61
    v_fma_f32 v44, v44, s52, 1.0
    v_mul_f32 v44, v44, v61
    v_mul_f32 v44, s53, v44
    v_exp_f32 v44, v44
    s_nop 0
    v_add_f32 v44, 1.0, v44
    v_rcp_f32 v44, v44
    s_nop 0
    v_mul_f32 v61, v61, v44
    v_add_f32 v62, v62, v38
    v_mul_f32 v44, v62, v62
    v_fma_f32 v44, v44, s52, 1.0
    v_mul_f32 v44, v44, v62
    v_mul_f32 v44, s53, v44
    v_exp_f32 v44, v44
    s_nop 0
    v_add_f32 v44, 1.0, v44
    v_rcp_f32 v44, v44
    s_nop 0
    v_mul_f32 v62, v62, v44
    v_add_f32 v63, v63, v39
    v_mul_f32 v44, v63, v63
    v_fma_f32 v44, v44, s52, 1.0
    v_mul_f32 v44, v44, v63
    v_mul_f32 v44, s53, v44
    v_exp_f32 v44, v44
    s_nop 0
    v_add_f32 v44, 1.0, v44
    v_rcp_f32 v44, v44
    s_nop 0
    v_mul_f32 v63, v63, v44
    v_add_f32 v64, v64, v40
    v_mul_f32 v44, v64, v64
    v_fma_f32 v44, v44, s52, 1.0
    v_mul_f32 v44, v44, v64
    v_mul_f32 v44, s53, v44
    v_exp_f32 v44, v44
    s_nop 0
    v_add_f32 v44, 1.0, v44
    v_rcp_f32 v44, v44
    s_nop 0
    v_mul_f32 v64, v64, v44
    v_add_f32 v65, v65, v41
    v_mul_f32 v44, v65, v65
    v_fma_f32 v44, v44, s52, 1.0
    v_mul_f32 v44, v44, v65
    v_mul_f32 v44, s53, v44
    v_exp_f32 v44, v44
    s_nop 0
    v_add_f32 v44, 1.0, v44
    v_rcp_f32 v44, v44
    s_nop 0
    v_mul_f32 v65, v65, v44
    v_add_f32 v66, v66, v42
    v_mul_f32 v44, v66, v66
    v_fma_f32 v44, v44, s52, 1.0
    v_mul_f32 v44, v44, v66
    v_mul_f32 v44, s53, v44
    v_exp_f32 v44, v44
    s_nop 0
    v_add_f32 v44, 1.0, v44
    v_rcp_f32 v44, v44
    s_nop 0
    v_mul_f32 v66, v66, v44
    v_add_f32 v67, v67, v43
    v_mul_f32 v44, v67, v67
    v_fma_f32 v44, v44, s52, 1.0
    v_mul_f32 v44, v44, v67
    v_mul_f32 v44, s53, v44
    v_exp_f32 v44, v44
    s_nop 0
    v_add_f32 v44, 1.0, v44
    v_rcp_f32 v44, v44
    s_nop 0
    v_mul_f32 v67, v67, v44
    v_cvt_pk_bf16_f32 v20, v52, v53
    v_cvt_pk_bf16_f32 v21, v54, v55
    v_cvt_pk_bf16_f32 v22, v56, v57
    v_cvt_pk_bf16_f32 v23, v58, v59
    v_cvt_pk_bf16_f32 v24, v60, v61
    v_cvt_pk_bf16_f32 v25, v62, v63
    v_cvt_pk_bf16_f32 v26, v64, v65
    v_cvt_pk_bf16_f32 v27, v66, v67
    s_mov_b32 s24, 0
    buffer_store_dwordx4 v[20:23], v4, s[12:15], s24 offen offset:0
    buffer_store_dwordx4 v[24:27], v4, s[12:15], s24 offen offset:32
    s_nop 1
    v_add_f32 v68, v68, v28
    v_mul_f32 v44, v68, v68
    v_fma_f32 v44, v44, s52, 1.0
    v_mul_f32 v44, v44, v68
    v_mul_f32 v44, s53, v44
    v_exp_f32 v44, v44
    s_nop 0
    v_add_f32 v44, 1.0, v44
    v_rcp_f32 v44, v44
    s_nop 0
    v_mul_f32 v68, v68, v44
    v_add_f32 v69, v69, v29
    v_mul_f32 v44, v69, v69
    v_fma_f32 v44, v44, s52, 1.0
    v_mul_f32 v44, v44, v69
    v_mul_f32 v44, s53, v44
    v_exp_f32 v44, v44
    s_nop 0
    v_add_f32 v44, 1.0, v44
    v_rcp_f32 v44, v44
    s_nop 0
    v_mul_f32 v69, v69, v44
    v_add_f32 v70, v70, v30
    v_mul_f32 v44, v70, v70
    v_fma_f32 v44, v44, s52, 1.0
    v_mul_f32 v44, v44, v70
    v_mul_f32 v44, s53, v44
    v_exp_f32 v44, v44
    s_nop 0
    v_add_f32 v44, 1.0, v44
    v_rcp_f32 v44, v44
    s_nop 0
    v_mul_f32 v70, v70, v44
    v_add_f32 v71, v71, v31
    v_mul_f32 v44, v71, v71
    v_fma_f32 v44, v44, s52, 1.0
    v_mul_f32 v44, v44, v71
    v_mul_f32 v44, s53, v44
    v_exp_f32 v44, v44
    s_nop 0
    v_add_f32 v44, 1.0, v44
    v_rcp_f32 v44, v44
    s_nop 0
    v_mul_f32 v71, v71, v44
    v_add_f32 v72, v72, v32
    v_mul_f32 v44, v72, v72
    v_fma_f32 v44, v44, s52, 1.0
    v_mul_f32 v44, v44, v72
    v_mul_f32 v44, s53, v44
    v_exp_f32 v44, v44
    s_nop 0
    v_add_f32 v44, 1.0, v44
    v_rcp_f32 v44, v44
    s_nop 0
    v_mul_f32 v72, v72, v44
    v_add_f32 v73, v73, v33
    v_mul_f32 v44, v73, v73
    v_fma_f32 v44, v44, s52, 1.0
    v_mul_f32 v44, v44, v73
    v_mul_f32 v44, s53, v44
    v_exp_f32 v44, v44
    s_nop 0
    v_add_f32 v44, 1.0, v44
    v_rcp_f32 v44, v44
    s_nop 0
    v_mul_f32 v73, v73, v44
    v_add_f32 v74, v74, v34
    v_mul_f32 v44, v74, v74
    v_fma_f32 v44, v44, s52, 1.0
    v_mul_f32 v44, v44, v74
    v_mul_f32 v44, s53, v44
    v_exp_f32 v44, v44
    s_nop 0
    v_add_f32 v44, 1.0, v44
    v_rcp_f32 v44, v44
    s_nop 0
    v_mul_f32 v74, v74, v44
    v_add_f32 v75, v75, v35
    v_mul_f32 v44, v75, v75
    v_fma_f32 v44, v44, s52, 1.0
    v_mul_f32 v44, v44, v75
    v_mul_f32 v44, s53, v44
    v_exp_f32 v44, v44
    s_nop 0
    v_add_f32 v44, 1.0, v44
    v_rcp_f32 v44, v44
    s_nop 0
    v_mul_f32 v75, v75, v44
    v_add_f32 v76, v76, v36
    v_mul_f32 v44, v76, v76
    v_fma_f32 v44, v44, s52, 1.0
    v_mul_f32 v44, v44, v76
    v_mul_f32 v44, s53, v44
    v_exp_f32 v44, v44
    s_nop 0
    v_add_f32 v44, 1.0, v44
    v_rcp_f32 v44, v44
    s_nop 0
    v_mul_f32 v76, v76, v44
    v_add_f32 v77, v77, v37
    v_mul_f32 v44, v77, v77
    v_fma_f32 v44, v44, s52, 1.0
    v_mul_f32 v44, v44, v77
    v_mul_f32 v44, s53, v44
    v_exp_f32 v44, v44
    s_nop 0
    v_add_f32 v44, 1.0, v44
    v_rcp_f32 v44, v44
    s_nop 0
    v_mul_f32 v77, v77, v44
    v_add_f32 v78, v78, v38
    v_mul_f32 v44, v78, v78
    v_fma_f32 v44, v44, s52, 1.0
    v_mul_f32 v44, v44, v78
    v_mul_f32 v44, s53, v44
    v_exp_f32 v44, v44
    s_nop 0
    v_add_f32 v44, 1.0, v44
    v_rcp_f32 v44, v44
    s_nop 0
    v_mul_f32 v78, v78, v44
    v_add_f32 v79, v79, v39
    v_mul_f32 v44, v79, v79
    v_fma_f32 v44, v44, s52, 1.0
    v_mul_f32 v44, v44, v79
    v_mul_f32 v44, s53, v44
    v_exp_f32 v44, v44
    s_nop 0
    v_add_f32 v44, 1.0, v44
    v_rcp_f32 v44, v44
    s_nop 0
    v_mul_f32 v79, v79, v44
    v_add_f32 v80, v80, v40
    v_mul_f32 v44, v80, v80
    v_fma_f32 v44, v44, s52, 1.0
    v_mul_f32 v44, v44, v80
    v_mul_f32 v44, s53, v44
    v_exp_f32 v44, v44
    s_nop 0
    v_add_f32 v44, 1.0, v44
    v_rcp_f32 v44, v44
    s_nop 0
    v_mul_f32 v80, v80, v44
    v_add_f32 v81, v81, v41
    v_mul_f32 v44, v81, v81
    v_fma_f32 v44, v44, s52, 1.0
    v_mul_f32 v44, v44, v81
    v_mul_f32 v44, s53, v44
    v_exp_f32 v44, v44
    s_nop 0
    v_add_f32 v44, 1.0, v44
    v_rcp_f32 v44, v44
    s_nop 0
    v_mul_f32 v81, v81, v44
    v_add_f32 v82, v82, v42
    v_mul_f32 v44, v82, v82
    v_fma_f32 v44, v44, s52, 1.0
    v_mul_f32 v44, v44, v82
    v_mul_f32 v44, s53, v44
    v_exp_f32 v44, v44
    s_nop 0
    v_add_f32 v44, 1.0, v44
    v_rcp_f32 v44, v44
    s_nop 0
    v_mul_f32 v82, v82, v44
    v_add_f32 v83, v83, v43
    v_mul_f32 v44, v83, v83
    v_fma_f32 v44, v44, s52, 1.0
    v_mul_f32 v44, v44, v83
    v_mul_f32 v44, s53, v44
    v_exp_f32 v44, v44
    s_nop 0
    v_add_f32 v44, 1.0, v44
    v_rcp_f32 v44, v44
    s_nop 0
    v_mul_f32 v83, v83, v44
    v_cvt_pk_bf16_f32 v20, v68, v69
    v_cvt_pk_bf16_f32 v21, v70, v71
    v_cvt_pk_bf16_f32 v22, v72, v73
    v_cvt_pk_bf16_f32 v23, v74, v75
    v_cvt_pk_bf16_f32 v24, v76, v77
    v_cvt_pk_bf16_f32 v25, v78, v79
    v_cvt_pk_bf16_f32 v26, v80, v81
    v_cvt_pk_bf16_f32 v27, v82, v83
    s_mov_b32 s24, 110592
    buffer_store_dwordx4 v[20:23], v4, s[12:15], s24 offen offset:0
    buffer_store_dwordx4 v[24:27], v4, s[12:15], s24 offen offset:32
    s_nop 1
p1_u_skip0:
    s_add_u32 s24, s50, 32
    s_cmp_ge_u32 s24, 1728
    s_cbranch_scc1 p1_u_skip1
    buffer_load_dwordx2 v[20:21], v5, s[16:19], 0 offen offset:64
    buffer_load_dwordx2 v[22:23], v5, s[16:19], 0 offen offset:80
    buffer_load_dwordx2 v[24:25], v5, s[16:19], 0 offen offset:96
    buffer_load_dwordx2 v[26:27], v5, s[16:19], 0 offen offset:112
    s_waitcnt vmcnt(0)
    v_lshlrev_b32 v28, 16, v20
    v_and_b32 v29, s51, v20
    v_lshlrev_b32 v30, 16, v21
    v_and_b32 v31, s51, v21
    v_lshlrev_b32 v32, 16, v22
    v_and_b32 v33, s51, v22
    v_lshlrev_b32 v34, 16, v23
    v_and_b32 v35, s51, v23
    v_lshlrev_b32 v36, 16, v24
    v_and_b32 v37, s51, v24
    v_lshlrev_b32 v38, 16, v25
    v_and_b32 v39, s51, v25
    v_lshlrev_b32 v40, 16, v26
    v_and_b32 v41, s51, v26
    v_lshlrev_b32 v42, 16, v27
    v_and_b32 v43, s51, v27
    v_add_f32 v84, v84, v28
    v_mul_f32 v44, v84, v84
    v_fma_f32 v44, v44, s52, 1.0
    v_mul_f32 v44, v44, v84
    v_mul_f32 v44, s53, v44
    v_exp_f32 v44, v44
    s_nop 0
    v_add_f32 v44, 1.0, v44
    v_rcp_f32 v44, v44
    s_nop 0
    v_mul_f32 v84, v84, v44
    v_add_f32 v85, v85, v29
    v_mul_f32 v44, v85, v85
    v_fma_f32 v44, v44, s52, 1.0
    v_mul_f32 v44, v44, v85
    v_mul_f32 v44, s53, v44
    v_exp_f32 v44, v44
    s_nop 0
    v_add_f32 v44, 1.0, v44
    v_rcp_f32 v44, v44
    s_nop 0
    v_mul_f32 v85, v85, v44
    v_add_f32 v86, v86, v30
    v_mul_f32 v44, v86, v86
    v_fma_f32 v44, v44, s52, 1.0
    v_mul_f32 v44, v44, v86
    v_mul_f32 v44, s53, v44
    v_exp_f32 v44, v44
    s_nop 0
    v_add_f32 v44, 1.0, v44
    v_rcp_f32 v44, v44
    s_nop 0
    v_mul_f32 v86, v86, v44
    v_add_f32 v87, v87, v31
    v_mul_f32 v44, v87, v87
    v_fma_f32 v44, v44, s52, 1.0
    v_mul_f32 v44, v44, v87
    v_mul_f32 v44, s53, v44
    v_exp_f32 v44, v44
    s_nop 0
    v_add_f32 v44, 1.0, v44
    v_rcp_f32 v44, v44
    s_nop 0
    v_mul_f32 v87, v87, v44
    v_add_f32 v88, v88, v32
    v_mul_f32 v44, v88, v88
    v_fma_f32 v44, v44, s52, 1.0
    v_mul_f32 v44, v44, v88
    v_mul_f32 v44, s53, v44
    v_exp_f32 v44, v44
    s_nop 0
    v_add_f32 v44, 1.0, v44
    v_rcp_f32 v44, v44
    s_nop 0
    v_mul_f32 v88, v88, v44
    v_add_f32 v89, v89, v33
    v_mul_f32 v44, v89, v89
    v_fma_f32 v44, v44, s52, 1.0
    v_mul_f32 v44, v44, v89
    v_mul_f32 v44, s53, v44
    v_exp_f32 v44, v44
    s_nop 0
    v_add_f32 v44, 1.0, v44
    v_rcp_f32 v44, v44
    s_nop 0
    v_mul_f32 v89, v89, v44
    v_add_f32 v90, v90, v34
    v_mul_f32 v44, v90, v90
    v_fma_f32 v44, v44, s52, 1.0
    v_mul_f32 v44, v44, v90
    v_mul_f32 v44, s53, v44
    v_exp_f32 v44, v44
    s_nop 0
    v_add_f32 v44, 1.0, v44
    v_rcp_f32 v44, v44
    s_nop 0
    v_mul_f32 v90, v90, v44
    v_add_f32 v91, v91, v35
    v_mul_f32 v44, v91, v91
    v_fma_f32 v44, v44, s52, 1.0
    v_mul_f32 v44, v44, v91
    v_mul_f32 v44, s53, v44
    v_exp_f32 v44, v44
    s_nop 0
    v_add_f32 v44, 1.0, v44
    v_rcp_f32 v44, v44
    s_nop 0
    v_mul_f32 v91, v91, v44
    v_add_f32 v92, v92, v36
    v_mul_f32 v44, v92, v92
    v_fma_f32 v44, v44, s52, 1.0
    v_mul_f32 v44, v44, v92
    v_mul_f32 v44, s53, v44
    v_exp_f32 v44, v44
    s_nop 0
    v_add_f32 v44, 1.0, v44
    v_rcp_f32 v44, v44
    s_nop 0
    v_mul_f32 v92, v92, v44
    v_add_f32 v93, v93, v37
    v_mul_f32 v44, v93, v93
    v_fma_f32 v44, v44, s52, 1.0
    v_mul_f32 v44, v44, v93
    v_mul_f32 v44, s53, v44
    v_exp_f32 v44, v44
    s_nop 0
    v_add_f32 v44, 1.0, v44
    v_rcp_f32 v44, v44
    s_nop 0
    v_mul_f32 v93, v93, v44
    v_add_f32 v94, v94, v38
    v_mul_f32 v44, v94, v94
    v_fma_f32 v44, v44, s52, 1.0
    v_mul_f32 v44, v44, v94
    v_mul_f32 v44, s53, v44
    v_exp_f32 v44, v44
    s_nop 0
    v_add_f32 v44, 1.0, v44
    v_rcp_f32 v44, v44
    s_nop 0
    v_mul_f32 v94, v94, v44
    v_add_f32 v95, v95, v39
    v_mul_f32 v44, v95, v95
    v_fma_f32 v44, v44, s52, 1.0
    v_mul_f32 v44, v44, v95
    v_mul_f32 v44, s53, v44
    v_exp_f32 v44, v44
    s_nop 0
    v_add_f32 v44, 1.0, v44
    v_rcp_f32 v44, v44
    s_nop 0
    v_mul_f32 v95, v95, v44
    v_add_f32 v96, v96, v40
    v_mul_f32 v44, v96, v96
    v_fma_f32 v44, v44, s52, 1.0
    v_mul_f32 v44, v44, v96
    v_mul_f32 v44, s53, v44
    v_exp_f32 v44, v44
    s_nop 0
    v_add_f32 v44, 1.0, v44
    v_rcp_f32 v44, v44
    s_nop 0
    v_mul_f32 v96, v96, v44
    v_add_f32 v97, v97, v41
    v_mul_f32 v44, v97, v97
    v_fma_f32 v44, v44, s52, 1.0
    v_mul_f32 v44, v44, v97
    v_mul_f32 v44, s53, v44
    v_exp_f32 v44, v44
    s_nop 0
    v_add_f32 v44, 1.0, v44
    v_rcp_f32 v44, v44
    s_nop 0
    v_mul_f32 v97, v97, v44
    v_add_f32 v98, v98, v42
    v_mul_f32 v44, v98, v98
    v_fma_f32 v44, v44, s52, 1.0
    v_mul_f32 v44, v44, v98
    v_mul_f32 v44, s53, v44
    v_exp_f32 v44, v44
    s_nop 0
    v_add_f32 v44, 1.0, v44
    v_rcp_f32 v44, v44
    s_nop 0
    v_mul_f32 v98, v98, v44
    v_add_f32 v99, v99, v43
    v_mul_f32 v44, v99, v99
    v_fma_f32 v44, v44, s52, 1.0
    v_mul_f32 v44, v44, v99
    v_mul_f32 v44, s53, v44
    v_exp_f32 v44, v44
    s_nop 0
    v_add_f32 v44, 1.0, v44
    v_rcp_f32 v44, v44
    s_nop 0
    v_mul_f32 v99, v99, v44
    v_cvt_pk_bf16_f32 v20, v84, v85
    v_cvt_pk_bf16_f32 v21, v86, v87
    v_cvt_pk_bf16_f32 v22, v88, v89
    v_cvt_pk_bf16_f32 v23, v90, v91
    v_cvt_pk_bf16_f32 v24, v92, v93
    v_cvt_pk_bf16_f32 v25, v94, v95
    v_cvt_pk_bf16_f32 v26, v96, v97
    v_cvt_pk_bf16_f32 v27, v98, v99
    s_mov_b32 s24, 0
    buffer_store_dwordx4 v[20:23], v4, s[12:15], s24 offen offset:64
    buffer_store_dwordx4 v[24:27], v4, s[12:15], s24 offen offset:96
    s_nop 1
    v_add_f32 v100, v100, v28
    v_mul_f32 v44, v100, v100
    v_fma_f32 v44, v44, s52, 1.0
    v_mul_f32 v44, v44, v100
    v_mul_f32 v44, s53, v44
    v_exp_f32 v44, v44
    s_nop 0
    v_add_f32 v44, 1.0, v44
    v_rcp_f32 v44, v44
    s_nop 0
    v_mul_f32 v100, v100, v44
    v_add_f32 v101, v101, v29
    v_mul_f32 v44, v101, v101
    v_fma_f32 v44, v44, s52, 1.0
    v_mul_f32 v44, v44, v101
    v_mul_f32 v44, s53, v44
    v_exp_f32 v44, v44
    s_nop 0
    v_add_f32 v44, 1.0, v44
    v_rcp_f32 v44, v44
    s_nop 0
    v_mul_f32 v101, v101, v44
    v_add_f32 v102, v102, v30
    v_mul_f32 v44, v102, v102
    v_fma_f32 v44, v44, s52, 1.0
    v_mul_f32 v44, v44, v102
    v_mul_f32 v44, s53, v44
    v_exp_f32 v44, v44
    s_nop 0
    v_add_f32 v44, 1.0, v44
    v_rcp_f32 v44, v44
    s_nop 0
    v_mul_f32 v102, v102, v44
    v_add_f32 v103, v103, v31
    v_mul_f32 v44, v103, v103
    v_fma_f32 v44, v44, s52, 1.0
    v_mul_f32 v44, v44, v103
    v_mul_f32 v44, s53, v44
    v_exp_f32 v44, v44
    s_nop 0
    v_add_f32 v44, 1.0, v44
    v_rcp_f32 v44, v44
    s_nop 0
    v_mul_f32 v103, v103, v44
    v_add_f32 v104, v104, v32
    v_mul_f32 v44, v104, v104
    v_fma_f32 v44, v44, s52, 1.0
    v_mul_f32 v44, v44, v104
    v_mul_f32 v44, s53, v44
    v_exp_f32 v44, v44
    s_nop 0
    v_add_f32 v44, 1.0, v44
    v_rcp_f32 v44, v44
    s_nop 0
    v_mul_f32 v104, v104, v44
    v_add_f32 v105, v105, v33
    v_mul_f32 v44, v105, v105
    v_fma_f32 v44, v44, s52, 1.0
    v_mul_f32 v44, v44, v105
    v_mul_f32 v44, s53, v44
    v_exp_f32 v44, v44
    s_nop 0
    v_add_f32 v44, 1.0, v44
    v_rcp_f32 v44, v44
    s_nop 0
    v_mul_f32 v105, v105, v44
    v_add_f32 v106, v106, v34
    v_mul_f32 v44, v106, v106
    v_fma_f32 v44, v44, s52, 1.0
    v_mul_f32 v44, v44, v106
    v_mul_f32 v44, s53, v44
    v_exp_f32 v44, v44
    s_nop 0
    v_add_f32 v44, 1.0, v44
    v_rcp_f32 v44, v44
    s_nop 0
    v_mul_f32 v106, v106, v44
    v_add_f32 v107, v107, v35
    v_mul_f32 v44, v107, v107
    v_fma_f32 v44, v44, s52, 1.0
    v_mul_f32 v44, v44, v107
    v_mul_f32 v44, s53, v44
    v_exp_f32 v44, v44
    s_nop 0
    v_add_f32 v44, 1.0, v44
    v_rcp_f32 v44, v44
    s_nop 0
    v_mul_f32 v107, v107, v44
    v_add_f32 v108, v108, v36
    v_mul_f32 v44, v108, v108
    v_fma_f32 v44, v44, s52, 1.0
    v_mul_f32 v44, v44, v108
    v_mul_f32 v44, s53, v44
    v_exp_f32 v44, v44
    s_nop 0
    v_add_f32 v44, 1.0, v44
    v_rcp_f32 v44, v44
    s_nop 0
    v_mul_f32 v108, v108, v44
    v_add_f32 v109, v109, v37
    v_mul_f32 v44, v109, v109
    v_fma_f32 v44, v44, s52, 1.0
    v_mul_f32 v44, v44, v109
    v_mul_f32 v44, s53, v44
    v_exp_f32 v44, v44
    s_nop 0
    v_add_f32 v44, 1.0, v44
    v_rcp_f32 v44, v44
    s_nop 0
    v_mul_f32 v109, v109, v44
    v_add_f32 v110, v110, v38
    v_mul_f32 v44, v110, v110
    v_fma_f32 v44, v44, s52, 1.0
    v_mul_f32 v44, v44, v110
    v_mul_f32 v44, s53, v44
    v_exp_f32 v44, v44
    s_nop 0
    v_add_f32 v44, 1.0, v44
    v_rcp_f32 v44, v44
    s_nop 0
    v_mul_f32 v110, v110, v44
    v_add_f32 v111, v111, v39
    v_mul_f32 v44, v111, v111
    v_fma_f32 v44, v44, s52, 1.0
    v_mul_f32 v44, v44, v111
    v_mul_f32 v44, s53, v44
    v_exp_f32 v44, v44
    s_nop 0
    v_add_f32 v44, 1.0, v44
    v_rcp_f32 v44, v44
    s_nop 0
    v_mul_f32 v111, v111, v44
    v_add_f32 v112, v112, v40
    v_mul_f32 v44, v112, v112
    v_fma_f32 v44, v44, s52, 1.0
    v_mul_f32 v44, v44, v112
    v_mul_f32 v44, s53, v44
    v_exp_f32 v44, v44
    s_nop 0
    v_add_f32 v44, 1.0, v44
    v_rcp_f32 v44, v44
    s_nop 0
    v_mul_f32 v112, v112, v44
    v_add_f32 v113, v113, v41
    v_mul_f32 v44, v113, v113
    v_fma_f32 v44, v44, s52, 1.0
    v_mul_f32 v44, v44, v113
    v_mul_f32 v44, s53, v44
    v_exp_f32 v44, v44
    s_nop 0
    v_add_f32 v44, 1.0, v44
    v_rcp_f32 v44, v44
    s_nop 0
    v_mul_f32 v113, v113, v44
    v_add_f32 v114, v114, v42
    v_mul_f32 v44, v114, v114
    v_fma_f32 v44, v44, s52, 1.0
    v_mul_f32 v44, v44, v114
    v_mul_f32 v44, s53, v44
    v_exp_f32 v44, v44
    s_nop 0
    v_add_f32 v44, 1.0, v44
    v_rcp_f32 v44, v44
    s_nop 0
    v_mul_f32 v114, v114, v44
    v_add_f32 v115, v115, v43
    v_mul_f32 v44, v115, v115
    v_fma_f32 v44, v44, s52, 1.0
    v_mul_f32 v44, v44, v115
    v_mul_f32 v44, s53, v44
    v_exp_f32 v44, v44
    s_nop 0
    v_add_f32 v44, 1.0, v44
    v_rcp_f32 v44, v44
    s_nop 0
    v_mul_f32 v115, v115, v44
    v_cvt_pk_bf16_f32 v20, v100, v101
    v_cvt_pk_bf16_f32 v21, v102, v103
    v_cvt_pk_bf16_f32 v22, v104, v105
    v_cvt_pk_bf16_f32 v23, v106, v107
    v_cvt_pk_bf16_f32 v24, v108, v109
    v_cvt_pk_bf16_f32 v25, v110, v111
    v_cvt_pk_bf16_f32 v26, v112, v113
    v_cvt_pk_bf16_f32 v27, v114, v115
    s_mov_b32 s24, 110592
    buffer_store_dwordx4 v[20:23], v4, s[12:15], s24 offen offset:64
    buffer_store_dwordx4 v[24:27], v4, s[12:15], s24 offen offset:96
    s_nop 1
p1_u_skip1:
p1_end:
    s_endpgm
.text
.globl attn_kernel
.p2align 8
.type attn_kernel,@function
attn_kernel:
    s_cmp_ge_u32 s2, 256
    s_cbranch_scc1 at_end
    s_load_dwordx2 s[44:45], s[0:1], 104
    s_load_dwordx2 s[60:61], s[0:1], 96
    v_and_b32 v1, 63, v0
    v_lshrrev_b32 v2, 6, v0
    s_nop 0
    v_readfirstlane_b32 s20, v2
    s_nop 3
    s_lshr_b32 s21, s20, 2
    s_and_b32 s22, s20, 3
    s_and_b32 s3, s2, 7
    s_lshr_b32 s30, s2, 3
    s_lshr_b32 s23, s30, 3
    s_lshl_b32 s3, s3, 2
    s_add_u32 s23, s23, s3
    s_and_b32 s24, s30, 7
    s_waitcnt lgkmcnt(0)
    s_add_u32 s4, s44, 0x1000000
    s_addc_u32 s5, s45, 0
    s_mov_b32 s6, 0x1000000
    s_mov_b32 s7, 0x00020000
    s_add_u32 s8, s44, 0x2000000
    s_addc_u32 s9, s45, 0
    s_mov_b32 s10, 0x1000000
    s_mov_b32 s11, 0x00020000
    s_add_u32 s12, s44, 0x3000000
    s_addc_u32 s13, s45, 0
    s_mov_b32 s14, 0x1000000
    s_mov_b32 s15, 0x00020000
    s_add_u32 s16, s44, 0x5000000
    s_addc_u32 s17, s45, 0
    s_mov_b32 s18, 0x1000000
    s_mov_b32 s19, 0x00020000
    s_mov_b32 s34, 0x3e0293ee
    s_lshl_b32 s30, s20, 4
    s_add_u32 s30, s30, 0
    v_lshrrev_b32 v2, 4, v1
    v_add_u32 v2, s30, v2
    v_xor_b32 v3, v2, v1
    v_and_b32 v3, 15, v3
    v_lshlrev_b32 v3, 4, v3
    v_lshl_add_u32 v6, v2, 8, v3
    v_mov_b32 v10, v6
    s_lshl_b32 s30, s20, 4
    s_add_u32 s30, s30, 4
    v_lshrrev_b32 v2, 4, v1
    v_add_u32 v2, s30, v2
    v_xor_b32 v3, v2, v1
    v_and_b32 v3, 15, v3
    v_lshlrev_b32 v3, 4, v3
    v_lshl_add_u32 v7, v2, 8, v3
    v_subrev_u32 v7, 1024, v7
    v_mov_b32 v11, v7
    s_lshl_b32 s30, s20, 4
    s_add_u32 s30, s30, 8
    v_lshrrev_b32 v2, 4, v1
    v_add_u32 v2, s30, v2
    v_xor_b32 v3, v2, v1
    v_and_b32 v3, 15, v3
    v_lshlrev_b32 v3, 4, v3
    v_lshl_add_u32 v8, v2, 8, v3
    v_subrev_u32 v8, 2048, v8
    v_mov_b32 v12, v8
    s_lshl_b32 s30, s20, 4
    s_add_u32 s30, s30, 12
    v_lshrrev_b32 v2, 4, v1
    v_add_u32 v2, s30, v2
    v_xor_b32 v3, v2, v1
    v_and_b32 v3, 15, v3
    v_lshlrev_b32 v3, 4, v3
    v_lshl_add_u32 v9, v2, 8, v3
    v_subrev_u32 v9, 3072, v9
    v_mov_b32 v13, v9
    v_and_b32 v2, 31, v1
    v_lshrrev_b32 v3, 5, v1
    v_and_b32 v4, 15, v1
    v_xor_b32 v4, v4, v3
    v_lshlrev_b32 v4, 4, v4
    s_lshl_b32 s30, s21, 6
    v_add_u32 v32, s30, v2
    v_lshl_add_u32 v32, v32, 8, v4
    v_xor_b32 v14, 0, v32
    v_xor_b32 v15, 32, v32
    v_xor_b32 v16, 64, v32
    v_xor_b32 v17, 96, v32
    v_xor_b32 v18, 128, v32
    v_xor_b32 v19, 160, v32
    v_xor_b32 v20, 192, v32
    v_xor_b32 v21, 224, v32
    v_lshl_add_u32 v32, v2, 8, v4
    v_add_u32 v32, 65536, v32
    s_lshl_b32 s30, s21, 7
    v_xor_b32 v32, s30, v32
    v_xor_b32 v22, 0, v32
    v_xor_b32 v23, 32, v32
    v_xor_b32 v24, 64, v32
    v_xor_b32 v25, 96, v32
    s_lshl_b32 s30, s22, 5
    s_lshl_b32 s31, s21, 6
    s_sub_u32 s30, s30, s31
    v_add_u32 v28, s30, v2
    v_lshlrev_b32 v3, 2, v3
    v_sub_u32 v28, v28, v3
    s_mov_b32 s35, 0
    v_mov_b32 v34, s34
    v_mov_b32 v35, s34
    s_sub_u32 s25, 15, s24
    s_lshl_b32 s36, s25, 7
    s_lshl_b32 s30, s22, 5
    s_add_u32 s30, s30, s36
    v_and_b32 v2, 31, v1
    v_add_u32 v2, s30, v2
    v_lshrrev_b32 v3, 5, v1
    v_lshlrev_b32 v3, 4, v3
    v_lshl_add_u32 v4, v2, 8, v3
    v_lshl_add_u32 v2, v2, 13, v3
    s_lshl_b32 s30, s23, 8
    v_add_u32 v29, s30, v2
    s_lshl_b32 s30, s23, 19
    buffer_load_dwordx4 v[36:39], v4, s[4:7], s30 offen offset:0
    buffer_load_dwordx4 v[40:43], v4, s[4:7], s30 offen offset:32
    buffer_load_dwordx4 v[44:47], v4, s[4:7], s30 offen offset:64
    buffer_load_dwordx4 v[48:51], v4, s[4:7], s30 offen offset:96
    buffer_load_dwordx4 v[52:55], v4, s[4:7], s30 offen offset:128
    buffer_load_dwordx4 v[56:59], v4, s[4:7], s30 offen offset:160
    buffer_load_dwordx4 v[60:63], v4, s[4:7], s30 offen offset:192
    buffer_load_dwordx4 v[64:67], v4, s[4:7], s30 offen offset:224
    s_lshl_b32 s27, s23, 19
    s_lshl_b32 s28, s23, 19
    s_mov_b32 s29, 0
    s_mov_b32 s37, 0
    s_mov_b32 s38, 0
    s_mov_b32 s39, 0
    s_lshl_b32 s30, s20, 12
    s_add_u32 s40, s30, s29
    s_add_u32 s41, s30, s37
    s_add_u32 s41, s41, 65536
    s_mov_b32 m0, s40
    s_nop 0
    buffer_load_dwordx4 v6, s[8:11], s27 offen offset:0 lds
    buffer_load_dwordx4 v7, s[8:11], s27 offen offset:1024 lds
    buffer_load_dwordx4 v8, s[8:11], s27 offen offset:2048 lds
    buffer_load_dwordx4 v9, s[8:11], s27 offen offset:3072 lds
    s_mov_b32 m0, s41
    s_nop 0
    buffer_load_dwordx4 v10, s[12:15], s28 offen offset:0 lds
    buffer_load_dwordx4 v11, s[12:15], s28 offen offset:1024 lds
    buffer_load_dwordx4 v12, s[12:15], s28 offen offset:2048 lds
    buffer_load_dwordx4 v13, s[12:15], s28 offen offset:3072 lds
    s_add_u32 s27, s27, 32768
    s_add_u32 s28, s28, 32768
    s_xor_b32 s29, s29, 32768
    s_add_u32 s37, s37, 32768
    s_cmp_eq_u32 s37, 98304
    s_cselect_b32 s37, 0, s37
at_qblock:
    v_mov_b32 v26, 0xf149f2ca
    v_mov_b32 v27, 0
    v_mov_b32 v180, 0
    v_mov_b32 v181, 0
    v_mov_b32 v182, 0
    v_mov_b32 v183, 0
    v_mov_b32 v184, 0
    v_mov_b32 v185, 0
    v_mov_b32 v186, 0
    v_mov_b32 v187, 0
    v_mov_b32 v188, 0
    v_mov_b32 v189, 0
    v_mov_b32 v190, 0
    v_mov_b32 v191, 0
    v_mov_b32 v192, 0
    v_mov_b32 v193, 0
    v_mov_b32 v194, 0
    v_mov_b32 v195, 0
    v_mov_b32 v196, 0
    v_mov_b32 v197, 0
    v_mov_b32 v198, 0
    v_mov_b32 v199, 0
    v_mov_b32 v200, 0
    v_mov_b32 v201, 0
    v_mov_b32 v202, 0
    v_mov_b32 v203, 0
    v_mov_b32 v204, 0
    v_mov_b32 v205, 0
    v_mov_b32 v206, 0
    v_mov_b32 v207, 0
    v_mov_b32 v208, 0
    v_mov_b32 v209, 0
    v_mov_b32 v210, 0
    v_mov_b32 v211, 0
    v_mov_b32 v212, 0
    v_mov_b32 v213, 0
    v_mov_b32 v214, 0
    v_mov_b32 v215, 0
    v_mov_b32 v216, 0
    v_mov_b32 v217, 0
    v_mov_b32 v218, 0
    v_mov_b32 v219, 0
    v_mov_b32 v220, 0
    v_mov_b32 v221, 0
    v_mov_b32 v222, 0
    v_mov_b32 v223, 0
    v_mov_b32 v224, 0
    v_mov_b32 v225, 0
    v_mov_b32 v226, 0
    v_mov_b32 v227, 0
    v_mov_b32 v228, 0
    v_mov_b32 v229, 0
    v_mov_b32 v230, 0
    v_mov_b32 v231, 0
    v_mov_b32 v232, 0
    v_mov_b32 v233, 0
    v_mov_b32 v234, 0
    v_mov_b32 v235, 0
    v_mov_b32 v236, 0
    v_mov_b32 v237, 0
    v_mov_b32 v238, 0
    v_mov_b32 v239, 0
    v_mov_b32 v240, 0
    v_mov_b32 v241, 0
    v_mov_b32 v242, 0
    v_mov_b32 v243, 0
    s_mov_b32 s26, 0
    s_cmp_eq_u32 s21, 1
    s_cbranch_scc1 at1_loop
at0_loop:
    s_waitcnt vmcnt(0)
    s_barrier
    s_cmp_lg_u32 s26, s25
    s_cselect_b32 s42, 1, 0
    s_lshl_b32 s30, s20, 12
    s_add_u32 s40, s30, s29
    s_add_u32 s41, s30, s37
    s_add_u32 s41, s41, 65536
    s_cmp_eq_u32 s26, 0
    s_cbranch_scc1 at0_first
    s_waitcnt lgkmcnt(0)
    s_nop 1
    v_mfma_f32_32x32x16_bf16 v[180:195], v[116:119], v[100:103], v[180:195]
    v_mfma_f32_32x32x16_bf16 v[180:195], v[120:123], v[104:107], v[180:195]
    s_cmp_eq_u32 s42, 0
    s_cbranch_scc1 at_np1
    s_mov_b32 m0, s40
    s_nop 0
    buffer_load_dwordx4 v6, s[8:11], s27 offen offset:0 lds
at_np1:
    v_mfma_f32_32x32x16_bf16 v[180:195], v[124:127], v[108:111], v[180:195]
    v_mfma_f32_32x32x16_bf16 v[180:195], v[128:131], v[112:115], v[180:195]
    s_cmp_eq_u32 s42, 0
    s_cbranch_scc1 at_np2
    buffer_load_dwordx4 v7, s[8:11], s27 offen offset:1024 lds
at_np2:
    v_mfma_f32_32x32x16_bf16 v[196:211], v[132:135], v[100:103], v[196:211]
    v_mfma_f32_32x32x16_bf16 v[196:211], v[136:139], v[104:107], v[196:211]
    s_cmp_eq_u32 s42, 0
    s_cbranch_scc1 at_np3
    buffer_load_dwordx4 v8, s[8:11], s27 offen offset:2048 lds
at_np3:
    v_mfma_f32_32x32x16_bf16 v[196:211], v[140:143], v[108:111], v[196:211]
    v_mfma_f32_32x32x16_bf16 v[196:211], v[144:147], v[112:115], v[196:211]
    s_cmp_eq_u32 s42, 0
    s_cbranch_scc1 at_np4
    buffer_load_dwordx4 v9, s[8:11], s27 offen offset:3072 lds
at_np4:
    ds_read_b128 v[116:119], v14 offset:0
    ds_read_b128 v[120:123], v15 offset:0
    ds_read_b128 v[124:127], v16 offset:0
    ds_read_b128 v[128:131], v17 offset:0
    ds_read_b128 v[132:135], v18 offset:0
    ds_read_b128 v[136:139], v19 offset:0
    ds_read_b128 v[140:143], v20 offset:0
    ds_read_b128 v[144:147], v21 offset:0
    v_mfma_f32_32x32x16_bf16 v[212:227], v[148:151], v[100:103], v[212:227]
    v_mfma_f32_32x32x16_bf16 v[212:227], v[152:155], v[104:107], v[212:227]
    s_cmp_eq_u32 s42, 0
    s_cbranch_scc1 at_np5
    s_mov_b32 m0, s41
    s_nop 0
    buffer_load_dwordx4 v10, s[12:15], s28 offen offset:0 lds
at_np5:
    v_mfma_f32_32x32x16_bf16 v[212:227], v[156:159], v[108:111], v[212:227]
    v_mfma_f32_32x32x16_bf16 v[212:227], v[160:163], v[112:115], v[212:227]
    s_cmp_eq_u32 s42, 0
    s_cbranch_scc1 at_np6
    buffer_load_dwordx4 v11, s[12:15], s28 offen offset:1024 lds
at_np6:
    v_mfma_f32_32x32x16_bf16 v[228:243], v[164:167], v[100:103], v[228:243]
    v_mfma_f32_32x32x16_bf16 v[228:243], v[168:171], v[104:107], v[228:243]
    s_cmp_eq_u32 s42, 0
    s_cbranch_scc1 at_np7
    buffer_load_dwordx4 v12, s[12:15], s28 offen offset:2048 lds
at_np7:
    v_mfma_f32_32x32x16_bf16 v[228:243], v[172:175], v[108:111], v[228:243]
    v_mfma_f32_32x32x16_bf16 v[228:243], v[176:179], v[112:115], v[228:243]
    s_cmp_eq_u32 s42, 0
    s_cbranch_scc1 at_np8
    buffer_load_dwordx4 v13, s[12:15], s28 offen offset:3072 lds
    s_add_u32 s27, s27, 32768
    s_add_u32 s28, s28, 32768
    s_xor_b32 s29, s29, 32768
    s_add_u32 s37, s37, 32768
    s_cmp_eq_u32 s37, 98304
    s_cselect_b32 s37, 0, s37
at_np8:
    ds_read_b128 v[148:151], v14 offset:8192
    ds_read_b128 v[152:155], v15 offset:8192
    ds_read_b128 v[156:159], v16 offset:8192
    ds_read_b128 v[160:163], v17 offset:8192
    ds_read_b128 v[164:167], v18 offset:8192
    ds_read_b128 v[168:171], v19 offset:8192
    ds_read_b128 v[172:175], v20 offset:8192
    ds_read_b128 v[176:179], v21 offset:8192
    s_waitcnt lgkmcnt(8)
    v_mfma_f32_32x32x16_bf16 v[68:83], v[116:119], v[36:39], 0
    v_mfma_f32_32x32x16_bf16 v[68:83], v[120:123], v[40:43], v[68:83]
    v_mfma_f32_32x32x16_bf16 v[68:83], v[124:127], v[44:47], v[68:83]
    v_mfma_f32_32x32x16_bf16 v[68:83], v[128:131], v[48:51], v[68:83]
    v_mfma_f32_32x32x16_bf16 v[68:83], v[132:135], v[52:55], v[68:83]
    v_mfma_f32_32x32x16_bf16 v[68:83], v[136:139], v[56:59], v[68:83]
    v_mfma_f32_32x32x16_bf16 v[68:83], v[140:143], v[60:63], v[68:83]
    v_mfma_f32_32x32x16_bf16 v[68:83], v[144:147], v[64:67], v[68:83]
    s_waitcnt lgkmcnt(0)
    v_mfma_f32_32x32x16_bf16 v[84:99], v[148:151], v[36:39], 0
    v_mfma_f32_32x32x16_bf16 v[84:99], v[152:155], v[40:43], v[84:99]
    v_mfma_f32_32x32x16_bf16 v[84:99], v[156:159], v[44:47], v[84:99]
    v_mfma_f32_32x32x16_bf16 v[84:99], v[160:163], v[48:51], v[84:99]
    v_mfma_f32_32x32x16_bf16 v[84:99], v[164:167], v[52:55], v[84:99]
    v_mfma_f32_32x32x16_bf16 v[84:99], v[168:171], v[56:59], v[84:99]
    v_mfma_f32_32x32x16_bf16 v[84:99], v[172:175], v[60:63], v[84:99]
    v_mfma_f32_32x32x16_bf16 v[84:99], v[176:179], v[64:67], v[84:99]
    v_xor_b32 v14, 0x8000, v14
    v_xor_b32 v15, 0x8000, v15
    v_xor_b32 v16, 0x8000, v16
    v_xor_b32 v17, 0x8000, v17
    v_xor_b32 v18, 0x8000, v18
    v_xor_b32 v19, 0x8000, v19
    v_xor_b32 v20, 0x8000, v20
    v_xor_b32 v21, 0x8000, v21
    s_xor_b32 s38, s38, 32768
    s_branch at0_sm
at0_first:
    ds_read_b128 v[116:119], v14 offset:0
    ds_read_b128 v[120:123], v15 offset:0
    ds_read_b128 v[124:127], v16 offset:0
    ds_read_b128 v[128:131], v17 offset:0
    ds_read_b128 v[132:135], v18 offset:0
    ds_read_b128 v[136:139], v19 offset:0
    ds_read_b128 v[140:143], v20 offset:0
    ds_read_b128 v[144:147], v21 offset:0
    ds_read_b128 v[148:151], v14 offset:8192
    ds_read_b128 v[152:155], v15 offset:8192
    ds_read_b128 v[156:159], v16 offset:8192
    ds_read_b128 v[160:163], v17 offset:8192
    ds_read_b128 v[164:167], v18 offset:8192
    ds_read_b128 v[168:171], v19 offset:8192
    ds_read_b128 v[172:175], v20 offset:8192
    ds_read_b128 v[176:179], v21 offset:8192
    s_waitcnt lgkmcnt(8)
    v_mfma_f32_32x32x16_bf16 v[68:83], v[116:119], v[36:39], 0
    v_mfma_f32_32x32x16_bf16 v[68:83], v[120:123], v[40:43], v[68:83]
    s_cmp_eq_u32 s42, 0
    s_cbranch_scc1 at_np9
    s_mov_b32 m0, s40
    s_nop 0
    buffer_load_dwordx4 v6, s[8:11], s27 offen offset:0 lds
at_np9:
    v_mfma_f32_32x32x16_bf16 v[68:83], v[124:127], v[44:47], v[68:83]
    v_mfma_f32_32x32x16_bf16 v[68:83], v[128:131], v[48:51], v[68:83]
    s_cmp_eq_u32 s42, 0
    s_cbranch_scc1 at_np10
    buffer_load_dwordx4 v7, s[8:11], s27 offen offset:1024 lds
at_np10:
    v_mfma_f32_32x32x16_bf16 v[68:83], v[132:135], v[52:55], v[68:83]
    v_mfma_f32_32x32x16_bf16 v[68:83], v[136:139], v[56:59], v[68:83]
    s_cmp_eq_u32 s42, 0
    s_cbranch_scc1 at_np11
    buffer_load_dwordx4 v8, s[8:11], s27 offen offset:2048 lds
at_np11:
    v_mfma_f32_32x32x16_bf16 v[68:83], v[140:143], v[60:63], v[68:83]
    v_mfma_f32_32x32x16_bf16 v[68:83], v[144:147], v[64:67], v[68:83]
    s_cmp_eq_u32 s42, 0
    s_cbranch_scc1 at_np12
    buffer_load_dwordx4 v9, s[8:11], s27 offen offset:3072 lds
at_np12:
    s_waitcnt lgkmcnt(0)
    v_mfma_f32_32x32x16_bf16 v[84:99], v[148:151], v[36:39], 0
    v_mfma_f32_32x32x16_bf16 v[84:99], v[152:155], v[40:43], v[84:99]
    s_cmp_eq_u32 s42, 0
    s_cbranch_scc1 at_np13
    s_mov_b32 m0, s41
    s_nop 0
    buffer_load_dwordx4 v10, s[12:15], s28 offen offset:0 lds
at_np13:
    v_mfma_f32_32x32x16_bf16 v[84:99], v[156:159], v[44:47], v[84:99]
    v_mfma_f32_32x32x16_bf16 v[84:99], v[160:163], v[48:51], v[84:99]
    s_cmp_eq_u32 s42, 0
    s_cbranch_scc1 at_np14
    buffer_load_dwordx4 v11, s[12:15], s28 offen offset:1024 lds
at_np14:
    v_mfma_f32_32x32x16_bf16 v[84:99], v[164:167], v[52:55], v[84:99]
    v_mfma_f32_32x32x16_bf16 v[84:99], v[168:171], v[56:59], v[84:99]
    s_cmp_eq_u32 s42, 0
    s_cbranch_scc1 at_np15
    buffer_load_dwordx4 v12, s[12:15], s28 offen offset:2048 lds
at_np15:
    v_mfma_f32_32x32x16_bf16 v[84:99], v[172:175], v[60:63], v[84:99]
    v_mfma_f32_32x32x16_bf16 v[84:99], v[176:179], v[64:67], v[84:99]
    s_cmp_eq_u32 s42, 0
    s_cbranch_scc1 at_np16
    buffer_load_dwordx4 v13, s[12:15], s28 offen offset:3072 lds
    s_add_u32 s27, s27, 32768
    s_add_u32 s28, s28, 32768
    s_xor_b32 s29, s29, 32768
    s_add_u32 s37, s37, 32768
    s_cmp_eq_u32 s37, 98304
    s_cselect_b32 s37, 0, s37
at_np16:
    v_xor_b32 v14, 0x8000, v14
    v_xor_b32 v15, 0x8000, v15
    v_xor_b32 v16, 0x8000, v16
    v_xor_b32 v17, 0x8000, v17
    v_xor_b32 v18, 0x8000, v18
    v_xor_b32 v19, 0x8000, v19
    v_xor_b32 v20, 0x8000, v20
    v_xor_b32 v21, 0x8000, v21
    s_xor_b32 s38, s38, 32768
at0_sm:
    s_nop 15
    s_cmp_lg_u32 s26, s25
    s_cbranch_scc1 at0_nomask
    v_mov_b32 v32, 0xf149f2ca
    v_cmp_gt_i32 vcc, 0, v28
    s_nop 1
    v_cndmask_b32 v68, v68, v32, vcc
    v_cmp_gt_i32 vcc, 1, v28
    s_nop 1
    v_cndmask_b32 v69, v69, v32, vcc
    v_cmp_gt_i32 vcc, 2, v28
    s_nop 1
    v_cndmask_b32 v70, v70, v32, vcc
    v_cmp_gt_i32 vcc, 3, v28
    s_nop 1
    v_cndmask_b32 v71, v71, v32, vcc
    v_cmp_gt_i32 vcc, 8, v28
    s_nop 1
    v_cndmask_b32 v72, v72, v32, vcc
    v_cmp_gt_i32 vcc, 9, v28
    s_nop 1
    v_cndmask_b32 v73, v73, v32, vcc
    v_cmp_gt_i32 vcc, 10, v28
    s_nop 1
    v_cndmask_b32 v74, v74, v32, vcc
    v_cmp_gt_i32 vcc, 11, v28
    s_nop 1
    v_cndmask_b32 v75, v75, v32, vcc
    v_cmp_gt_i32 vcc, 16, v28
    s_nop 1
    v_cndmask_b32 v76, v76, v32, vcc
    v_cmp_gt_i32 vcc, 17, v28
    s_nop 1
    v_cndmask_b32 v77, v77, v32, vcc
    v_cmp_gt_i32 vcc, 18, v28
    s_nop 1
    v_cndmask_b32 v78, v78, v32, vcc
    v_cmp_gt_i32 vcc, 19, v28
    s_nop 1
    v_cndmask_b32 v79, v79, v32, vcc
    v_cmp_gt_i32 vcc, 24, v28
    s_nop 1
    v_cndmask_b32 v80, v80, v32, vcc
    v_cmp_gt_i32 vcc, 25, v28
    s_nop 1
    v_cndmask_b32 v81, v81, v32, vcc
    v_cmp_gt_i32 vcc, 26, v28
    s_nop 1
    v_cndmask_b32 v82, v82, v32, vcc
    v_cmp_gt_i32 vcc, 27, v28
    s_nop 1
    v_cndmask_b32 v83, v83, v32, vcc
    v_cmp_gt_i32 vcc, 32, v28
    s_nop 1
    v_cndmask_b32 v84, v84, v32, vcc
    v_cmp_gt_i32 vcc, 33, v28
    s_nop 1
    v_cndmask_b32 v85, v85, v32, vcc
    v_cmp_gt_i32 vcc, 34, v28
    s_nop 1
    v_cndmask_b32 v86, v86, v32, vcc
    v_cmp_gt_i32 vcc, 35, v28
    s_nop 1
    v_cndmask_b32 v87, v87, v32, vcc
    v_cmp_gt_i32 vcc, 40, v28
    s_nop 1
    v_cndmask_b32 v88, v88, v32, vcc
    v_cmp_gt_i32 vcc, 41, v28
    s_nop 1
    v_cndmask_b32 v89, v89, v32, vcc
    v_cmp_gt_i32 vcc, 42, v28
    s_nop 1
    v_cndmask_b32 v90, v90, v32, vcc
    v_cmp_gt_i32 vcc, 43, v28
    s_nop 1
    v_cndmask_b32 v91, v91, v32, vcc
    v_cmp_gt_i32 vcc, 48, v28
    s_nop 1
    v_cndmask_b32 v92, v92, v32, vcc
    v_cmp_gt_i32 vcc, 49, v28
    s_nop 1
    v_cndmask_b32 v93, v93, v32, vcc
    v_cmp_gt_i32 vcc, 50, v28
    s_nop 1
    v_cndmask_b32 v94, v94, v32, vcc
    v_cmp_gt_i32 vcc, 51, v28
    s_nop 1
    v_cndmask_b32 v95, v95, v32, vcc
    v_cmp_gt_i32 vcc, 56, v28
    s_nop 1
    v_cndmask_b32 v96, v96, v32, vcc
    v_cmp_gt_i32 vcc, 57, v28
    s_nop 1
    v_cndmask_b32 v97, v97, v32, vcc
    v_cmp_gt_i32 vcc, 58, v28
    s_nop 1
    v_cndmask_b32 v98, v98, v32, vcc
    v_cmp_gt_i32 vcc, 59, v28
    s_nop 1
    v_cndmask_b32 v99, v99, v32, vcc
at0_nomask:
    s_setprio 1
    v_max3_f32 v32, v68, v69, v70
    v_max3_f32 v32, v32, v71, v72
    v_max3_f32 v32, v32, v73, v74
    v_max3_f32 v32, v32, v75, v76
    v_max3_f32 v32, v32, v77, v78
    v_max3_f32 v32, v32, v79, v80
    v_max3_f32 v32, v32, v81, v82
    v_max3_f32 v32, v32, v83, v84
    v_max3_f32 v32, v32, v85, v86
    v_max3_f32 v32, v32, v87, v88
    v_max3_f32 v32, v32, v89, v90
    v_max3_f32 v32, v32, v91, v92
    v_max3_f32 v32, v32, v93, v94
    v_max3_f32 v32, v32, v95, v96
    v_max3_f32 v32, v32, v97, v98
    v_max_f32 v32, v32, v99
    v_mov_b32 v33, v32
    s_nop 1
    v_permlane32_swap_b32 v32, v33
    s_nop 1
    v_max3_f32 v32, v32, v33, v26
    v_sub_f32 v30, v26, v32
    v_mul_f32 v30, s34, v30
    v_cmp_gt_f32 vcc, -8.0, v30
    s_nop 4
    s_cbranch_vccz at0_norescale
    v_exp_f32 v30, v30
    v_mov_b32 v26, v32
    v_mul_f32 v27, v27, v30
    v_mul_f32 v180, v180, v30
    v_mul_f32 v181, v181, v30
    v_mul_f32 v182, v182, v30
    v_mul_f32 v183, v183, v30
    v_mul_f32 v184, v184, v30
    v_mul_f32 v185, v185, v30
    v_mul_f32 v186, v186, v30
    v_mul_f32 v187, v187, v30
    v_mul_f32 v188, v188, v30
    v_mul_f32 v189, v189, v30
    v_mul_f32 v190, v190, v30
    v_mul_f32 v191, v191, v30
    v_mul_f32 v192, v192, v30
    v_mul_f32 v193, v193, v30
    v_mul_f32 v194, v194, v30
    v_mul_f32 v195, v195, v30
    v_mul_f32 v196, v196, v30
    v_mul_f32 v197, v197, v30
    v_mul_f32 v198, v198, v30
    v_mul_f32 v199, v199, v30
    v_mul_f32 v200, v200, v30
    v_mul_f32 v201, v201, v30
    v_mul_f32 v202, v202, v30
    v_mul_f32 v203, v203, v30
    v_mul_f32 v204, v204, v30
    v_mul_f32 v205, v205, v30
    v_mul_f32 v206, v206, v30
    v_mul_f32 v207, v207, v30
    v_mul_f32 v208, v208, v30
    v_mul_f32 v209, v209, v30
    v_mul_f32 v210, v210, v30
    v_mul_f32 v211, v211, v30
    v_mul_f32 v212, v212, v30
    v_mul_f32 v213, v213, v30
    v_mul_f32 v214, v214, v30
    v_mul_f32 v215, v215, v30
    v_mul_f32 v216, v216, v30
    v_mul_f32 v217, v217, v30
    v_mul_f32 v218, v218, v30
    v_mul_f32 v219, v219, v30
    v_mul_f32 v220, v220, v30
    v_mul_f32 v221, v221, v30
    v_mul_f32 v222, v222, v30
    v_mul_f32 v223, v223, v30
    v_mul_f32 v224, v224, v30
    v_mul_f32 v225, v225, v30
    v_mul_f32 v226, v226, v30
    v_mul_f32 v227, v227, v30
    v_mul_f32 v228, v228, v30
    v_mul_f32 v229, v229, v30
    v_mul_f32 v230, v230, v30
    v_mul_f32 v231, v231, v30
    v_mul_f32 v232, v232, v30
    v_mul_f32 v233, v233, v30
    v_mul_f32 v234, v234, v30
    v_mul_f32 v235, v235, v30
    v_mul_f32 v236, v236, v30
    v_mul_f32 v237, v237, v30
    v_mul_f32 v238, v238, v30
    v_mul_f32 v239, v239, v30
    v_mul_f32 v240, v240, v30
    v_mul_f32 v241, v241, v30
    v_mul_f32 v242, v242, v30
    v_mul_f32 v243, v243, v30
at0_norescale:
    v_mul_f32 v32, s34, v26
    v_sub_f32 v32, 0, v32
    v_mov_b32 v33, v32
    v_pk_fma_f32 v[68:69], v[68:69], v[34:35], v[32:33]
    v_exp_f32 v68, v68
    v_exp_f32 v69, v69
    v_pk_fma_f32 v[70:71], v[70:71], v[34:35], v[32:33]
    v_exp_f32 v70, v70
    v_exp_f32 v71, v71
    v_pk_fma_f32 v[72:73], v[72:73], v[34:35], v[32:33]
    v_exp_f32 v72, v72
    v_exp_f32 v73, v73
    v_pk_fma_f32 v[74:75], v[74:75], v[34:35], v[32:33]
    v_exp_f32 v74, v74
    v_exp_f32 v75, v75
    v_pk_fma_f32 v[76:77], v[76:77], v[34:35], v[32:33]
    v_exp_f32 v76, v76
    v_exp_f32 v77, v77
    v_pk_fma_f32 v[78:79], v[78:79], v[34:35], v[32:33]
    v_exp_f32 v78, v78
    v_exp_f32 v79, v79
    v_pk_fma_f32 v[80:81], v[80:81], v[34:35], v[32:33]
    v_exp_f32 v80, v80
    v_exp_f32 v81, v81
    v_pk_fma_f32 v[82:83], v[82:83], v[34:35], v[32:33]
    v_exp_f32 v82, v82
    v_exp_f32 v83, v83
    v_pk_fma_f32 v[84:85], v[84:85], v[34:35], v[32:33]
    v_exp_f32 v84, v84
    v_exp_f32 v85, v85
    v_pk_fma_f32 v[86:87], v[86:87], v[34:35], v[32:33]
    v_exp_f32 v86, v86
    v_exp_f32 v87, v87
    v_pk_fma_f32 v[88:89], v[88:89], v[34:35], v[32:33]
    v_exp_f32 v88, v88
    v_exp_f32 v89, v89
    v_pk_fma_f32 v[90:91], v[90:91], v[34:35], v[32:33]
    v_exp_f32 v90, v90
    v_exp_f32 v91, v91
    v_pk_fma_f32 v[92:93], v[92:93], v[34:35], v[32:33]
    v_exp_f32 v92, v92
    v_exp_f32 v93, v93
    v_pk_fma_f32 v[94:95], v[94:95], v[34:35], v[32:33]
    v_exp_f32 v94, v94
    v_exp_f32 v95, v95
    v_pk_fma_f32 v[96:97], v[96:97], v[34:35], v[32:33]
    v_exp_f32 v96, v96
    v_exp_f32 v97, v97
    v_pk_fma_f32 v[98:99], v[98:99], v[34:35], v[32:33]
    v_exp_f32 v98, v98
    v_exp_f32 v99, v99
    ds_read_b128 v[116:119], v22 offset:0
    ds_read_b128 v[120:123], v23 offset:0
    ds_read_b128 v[124:127], v24 offset:0
    ds_read_b128 v[128:131], v25 offset:0
    ds_read_b128 v[132:135], v22 offset:8192
    ds_read_b128 v[136:139], v23 offset:8192
    ds_read_b128 v[140:143], v24 offset:8192
    ds_read_b128 v[144:147], v25 offset:8192
    ds_read_b128 v[148:151], v22 offset:16384
    ds_read_b128 v[152:155], v23 offset:16384
    ds_read_b128 v[156:159], v24 offset:16384
    ds_read_b128 v[160:163], v25 offset:16384
    ds_read_b128 v[164:167], v22 offset:24576
    ds_read_b128 v[168:171], v23 offset:24576
    ds_read_b128 v[172:175], v24 offset:24576
    ds_read_b128 v[176:179], v25 offset:24576
    s_add_u32 s30, s39, 32768
    s_cmp_eq_u32 s30, 98304
    s_cselect_b32 s30, 0, s30
    s_sub_u32 s31, s30, s39
    s_mov_b32 s39, s30
    v_add_u32 v22, s31, v22
    v_add_u32 v23, s31, v23
    v_add_u32 v24, s31, v24
    v_add_u32 v25, s31, v25
    v_pk_add_f32 v[32:33], v[68:69], v[70:71]
    v_pk_add_f32 v[32:33], v[32:33], v[72:73]
    v_pk_add_f32 v[32:33], v[32:33], v[74:75]
    v_pk_add_f32 v[32:33], v[32:33], v[76:77]
    v_pk_add_f32 v[32:33], v[32:33], v[78:79]
    v_pk_add_f32 v[32:33], v[32:33], v[80:81]
    v_pk_add_f32 v[32:33], v[32:33], v[82:83]
    v_pk_add_f32 v[32:33], v[32:33], v[84:85]
    v_pk_add_f32 v[32:33], v[32:33], v[86:87]
    v_pk_add_f32 v[32:33], v[32:33], v[88:89]
    v_pk_add_f32 v[32:33], v[32:33], v[90:91]
    v_pk_add_f32 v[32:33], v[32:33], v[92:93]
    v_pk_add_f32 v[32:33], v[32:33], v[94:95]
    v_pk_add_f32 v[32:33], v[32:33], v[96:97]
    v_pk_add_f32 v[32:33], v[32:33], v[98:99]
    v_add_f32 v27, v27, v32
    v_add_f32 v27, v27, v33
    v_cvt_pk_bf16_f32 v100, v68, v69
    v_cvt_pk_bf16_f32 v101, v70, v71
    v_cvt_pk_bf16_f32 v102, v72, v73
    v_cvt_pk_bf16_f32 v103, v74, v75
    v_cvt_pk_bf16_f32 v104, v76, v77
    v_cvt_pk_bf16_f32 v105, v78, v79
    v_cvt_pk_bf16_f32 v106, v80, v81
    v_cvt_pk_bf16_f32 v107, v82, v83
    v_cvt_pk_bf16_f32 v108, v84, v85
    v_cvt_pk_bf16_f32 v109, v86, v87
    v_cvt_pk_bf16_f32 v110, v88, v89
    v_cvt_pk_bf16_f32 v111, v90, v91
    v_cvt_pk_bf16_f32 v112, v92, v93
    v_cvt_pk_bf16_f32 v113, v94, v95
    v_cvt_pk_bf16_f32 v114, v96, v97
    v_cvt_pk_bf16_f32 v115, v98, v99
    s_setprio 0
    s_add_u32 s26, s26, 1
    s_cmp_le_u32 s26, s25
    s_cbranch_scc1 at0_loop
    s_waitcnt lgkmcnt(0)
    s_nop 1
    v_mfma_f32_32x32x16_bf16 v[180:195], v[116:119], v[100:103], v[180:195]
    v_mfma_f32_32x32x16_bf16 v[180:195], v[120:123], v[104:107], v[180:195]
    v_mfma_f32_32x32x16_bf16 v[180:195], v[124:127], v[108:111], v[180:195]
    v_mfma_f32_32x32x16_bf16 v[180:195], v[128:131], v[112:115], v[180:195]
    v_mfma_f32_32x32x16_bf16 v[196:211], v[132:135], v[100:103], v[196:211]
    v_mfma_f32_32x32x16_bf16 v[196:211], v[136:139], v[104:107], v[196:211]
    v_mfma_f32_32x32x16_bf16 v[196:211], v[140:143], v[108:111], v[196:211]
    v_mfma_f32_32x32x16_bf16 v[196:211], v[144:147], v[112:115], v[196:211]
    v_mfma_f32_32x32x16_bf16 v[212:227], v[148:151], v[100:103], v[212:227]
    v_mfma_f32_32x32x16_bf16 v[212:227], v[152:155], v[104:107], v[212:227]
    v_mfma_f32_32x32x16_bf16 v[212:227], v[156:159], v[108:111], v[212:227]
    v_mfma_f32_32x32x16_bf16 v[212:227], v[160:163], v[112:115], v[212:227]
    v_mfma_f32_32x32x16_bf16 v[228:243], v[164:167], v[100:103], v[228:243]
    v_mfma_f32_32x32x16_bf16 v[228:243], v[168:171], v[104:107], v[228:243]
    v_mfma_f32_32x32x16_bf16 v[228:243], v[172:175], v[108:111], v[228:243]
    v_mfma_f32_32x32x16_bf16 v[228:243], v[176:179], v[112:115], v[228:243]
    s_branch at_done
at1_loop:
    s_waitcnt vmcnt(0)
    s_barrier
    s_cmp_lg_u32 s26, s25
    s_cselect_b32 s42, 1, 0
    s_lshl_b32 s30, s20, 12
    s_add_u32 s40, s30, s29
    s_add_u32 s41, s30, s37
    s_add_u32 s41, s41, 65536
    s_cmp_eq_u32 s26, 0
    s_cbranch_scc1 at1_first
    s_setprio 1
    v_max3_f32 v32, v68, v69, v70
    v_max3_f32 v32, v32, v71, v72
    v_max3_f32 v32, v32, v73, v74
    v_max3_f32 v32, v32, v75, v76
    v_max3_f32 v32, v32, v77, v78
    v_max3_f32 v32, v32, v79, v80
    v_max3_f32 v32, v32, v81, v82
    v_max3_f32 v32, v32, v83, v84
    v_max3_f32 v32, v32, v85, v86
    v_max3_f32 v32, v32, v87, v88
    v_max3_f32 v32, v32, v89, v90
    v_max3_f32 v32, v32, v91, v92
    v_max3_f32 v32, v32, v93, v94
    v_max3_f32 v32, v32, v95, v96
    v_max3_f32 v32, v32, v97, v98
    v_max_f32 v32, v32, v99
    v_mov_b32 v33, v32
    s_nop 1
    v_permlane32_swap_b32 v32, v33
    s_nop 1
    v_max3_f32 v32, v32, v33, v26
    v_sub_f32 v30, v26, v32
    v_mul_f32 v30, s34, v30
    v_cmp_gt_f32 vcc, -8.0, v30
    s_nop 4
    s_cbranch_vccz at1_norescale
    v_exp_f32 v30, v30
    v_mov_b32 v26, v32
    v_mul_f32 v27, v27, v30
    v_mul_f32 v180, v180, v30
    v_mul_f32 v181, v181, v30
    v_mul_f32 v182, v182, v30
    v_mul_f32 v183, v183, v30
    v_mul_f32 v184, v184, v30
    v_mul_f32 v185, v185, v30
    v_mul_f32 v186, v186, v30
    v_mul_f32 v187, v187, v30
    v_mul_f32 v188, v188, v30
    v_mul_f32 v189, v189, v30
    v_mul_f32 v190, v190, v30
    v_mul_f32 v191, v191, v30
    v_mul_f32 v192, v192, v30
    v_mul_f32 v193, v193, v30
    v_mul_f32 v194, v194, v30
    v_mul_f32 v195, v195, v30
    v_mul_f32 v196, v196, v30
    v_mul_f32 v197, v197, v30
    v_mul_f32 v198, v198, v30
    v_mul_f32 v199, v199, v30
    v_mul_f32 v200, v200, v30
    v_mul_f32 v201, v201, v30
    v_mul_f32 v202, v202, v30
    v_mul_f32 v203, v203, v30
    v_mul_f32 v204, v204, v30
    v_mul_f32 v205, v205, v30
    v_mul_f32 v206, v206, v30
    v_mul_f32 v207, v207, v30
    v_mul_f32 v208, v208, v30
    v_mul_f32 v209, v209, v30
    v_mul_f32 v210, v210, v30
    v_mul_f32 v211, v211, v30
    v_mul_f32 v212, v212, v30
    v_mul_f32 v213, v213, v30
    v_mul_f32 v214, v214, v30
    v_mul_f32 v215, v215, v30
    v_mul_f32 v216, v216, v30
    v_mul_f32 v217, v217, v30
    v_mul_f32 v218, v218, v30
    v_mul_f32 v219, v219, v30
    v_mul_f32 v220, v220, v30
    v_mul_f32 v221, v221, v30
    v_mul_f32 v222, v222, v30
    v_mul_f32 v223, v223, v30
    v_mul_f32 v224, v224, v30
    v_mul_f32 v225, v225, v30
    v_mul_f32 v226, v226, v30
    v_mul_f32 v227, v227, v30
    v_mul_f32 v228, v228, v30
    v_mul_f32 v229, v229, v30
    v_mul_f32 v230, v230, v30
    v_mul_f32 v231, v231, v30
    v_mul_f32 v232, v232, v30
    v_mul_f32 v233, v233, v30
    v_mul_f32 v234, v234, v30
    v_mul_f32 v235, v235, v30
    v_mul_f32 v236, v236, v30
    v_mul_f32 v237, v237, v30
    v_mul_f32 v238, v238, v30
    v_mul_f32 v239, v239, v30
    v_mul_f32 v240, v240, v30
    v_mul_f32 v241, v241, v30
    v_mul_f32 v242, v242, v30
    v_mul_f32 v243, v243, v30
at1_norescale:
    v_mul_f32 v32, s34, v26
    v_sub_f32 v32, 0, v32
    v_mov_b32 v33, v32
    v_pk_fma_f32 v[68:69], v[68:69], v[34:35], v[32:33]
    v_exp_f32 v68, v68
    v_exp_f32 v69, v69
    v_pk_fma_f32 v[70:71], v[70:71], v[34:35], v[32:33]
    v_exp_f32 v70, v70
    v_exp_f32 v71, v71
    v_pk_fma_f32 v[72:73], v[72:73], v[34:35], v[32:33]
    v_exp_f32 v72, v72
    v_exp_f32 v73, v73
    v_pk_fma_f32 v[74:75], v[74:75], v[34:35], v[32:33]
    v_exp_f32 v74, v74
    v_exp_f32 v75, v75
    v_pk_fma_f32 v[76:77], v[76:77], v[34:35], v[32:33]
    v_exp_f32 v76, v76
    v_exp_f32 v77, v77
    v_pk_fma_f32 v[78:79], v[78:79], v[34:35], v[32:33]
    v_exp_f32 v78, v78
    v_exp_f32 v79, v79
    v_pk_fma_f32 v[80:81], v[80:81], v[34:35], v[32:33]
    v_exp_f32 v80, v80
    v_exp_f32 v81, v81
    v_pk_fma_f32 v[82:83], v[82:83], v[34:35], v[32:33]
    v_exp_f32 v82, v82
    v_exp_f32 v83, v83
    v_pk_fma_f32 v[84:85], v[84:85], v[34:35], v[32:33]
    v_exp_f32 v84, v84
    v_exp_f32 v85, v85
    v_pk_fma_f32 v[86:87], v[86:87], v[34:35], v[32:33]
    v_exp_f32 v86, v86
    v_exp_f32 v87, v87
    v_pk_fma_f32 v[88:89], v[88:89], v[34:35], v[32:33]
    v_exp_f32 v88, v88
    v_exp_f32 v89, v89
    v_pk_fma_f32 v[90:91], v[90:91], v[34:35], v[32:33]
    v_exp_f32 v90, v90
    v_exp_f32 v91, v91
    v_pk_fma_f32 v[92:93], v[92:93], v[34:35], v[32:33]
    v_exp_f32 v92, v92
    v_exp_f32 v93, v93
    v_pk_fma_f32 v[94:95], v[94:95], v[34:35], v[32:33]
    v_exp_f32 v94, v94
    v_exp_f32 v95, v95
    v_pk_fma_f32 v[96:97], v[96:97], v[34:35], v[32:33]
    v_exp_f32 v96, v96
    v_exp_f32 v97, v97
    v_pk_fma_f32 v[98:99], v[98:99], v[34:35], v[32:33]
    v_exp_f32 v98, v98
    v_exp_f32 v99, v99
    ds_read_b128 v[116:119], v22 offset:0
    ds_read_b128 v[120:123], v23 offset:0
    ds_read_b128 v[124:127], v24 offset:0
    ds_read_b128 v[128:131], v25 offset:0
    ds_read_b128 v[132:135], v22 offset:8192
    ds_read_b128 v[136:139], v23 offset:8192
    ds_read_b128 v[140:143], v24 offset:8192
    ds_read_b128 v[144:147], v25 offset:8192
    ds_read_b128 v[148:151], v22 offset:16384
    ds_read_b128 v[152:155], v23 offset:16384
    ds_read_b128 v[156:159], v24 offset:16384
    ds_read_b128 v[160:163], v25 offset:16384
    ds_read_b128 v[164:167], v22 offset:24576
    ds_read_b128 v[168:171], v23 offset:24576
    ds_read_b128 v[172:175], v24 offset:24576
    ds_read_b128 v[176:179], v25 offset:24576
    s_add_u32 s30, s39, 32768
    s_cmp_eq_u32 s30, 98304
    s_cselect_b32 s30, 0, s30
    s_sub_u32 s31, s30, s39
    s_mov_b32 s39, s30
    v_add_u32 v22, s31, v22
    v_add_u32 v23, s31, v23
    v_add_u32 v24, s31, v24
    v_add_u32 v25, s31, v25
    v_pk_add_f32 v[32:33], v[68:69], v[70:71]
    v_pk_add_f32 v[32:33], v[32:33], v[72:73]
    v_pk_add_f32 v[32:33], v[32:33], v[74:75]
    v_pk_add_f32 v[32:33], v[32:33], v[76:77]
    v_pk_add_f32 v[32:33], v[32:33], v[78:79]
    v_pk_add_f32 v[32:33], v[32:33], v[80:81]
    v_pk_add_f32 v[32:33], v[32:33], v[82:83]
    v_pk_add_f32 v[32:33], v[32:33], v[84:85]
    v_pk_add_f32 v[32:33], v[32:33], v[86:87]
    v_pk_add_f32 v[32:33], v[32:33], v[88:89]
    v_pk_add_f32 v[32:33], v[32:33], v[90:91]
    v_pk_add_f32 v[32:33], v[32:33], v[92:93]
    v_pk_add_f32 v[32:33], v[32:33], v[94:95]
    v_pk_add_f32 v[32:33], v[32:33], v[96:97]
    v_pk_add_f32 v[32:33], v[32:33], v[98:99]
    v_add_f32 v27, v27, v32
    v_add_f32 v27, v27, v33
    v_cvt_pk_bf16_f32 v100, v68, v69
    v_cvt_pk_bf16_f32 v101, v70, v71
    v_cvt_pk_bf16_f32 v102, v72, v73
    v_cvt_pk_bf16_f32 v103, v74, v75
    v_cvt_pk_bf16_f32 v104, v76, v77
    v_cvt_pk_bf16_f32 v105, v78, v79
    v_cvt_pk_bf16_f32 v106, v80, v81
    v_cvt_pk_bf16_f32 v107, v82, v83
    v_cvt_pk_bf16_f32 v108, v84, v85
    v_cvt_pk_bf16_f32 v109, v86, v87
    v_cvt_pk_bf16_f32 v110, v88, v89
    v_cvt_pk_bf16_f32 v111, v90, v91
    v_cvt_pk_bf16_f32 v112, v92, v93
    v_cvt_pk_bf16_f32 v113, v94, v95
    v_cvt_pk_bf16_f32 v114, v96, v97
    v_cvt_pk_bf16_f32 v115, v98, v99
    s_setprio 0
    s_cmp_lg_u32 s26, s25
    s_cbranch_scc1 at1_doqk
    s_cmp_lt_u32 s22, 2
    s_cbranch_scc0 at1_doqk
    s_waitcnt lgkmcnt(0)
    s_nop 1
    v_mfma_f32_32x32x16_bf16 v[180:195], v[116:119], v[100:103], v[180:195]
    v_mfma_f32_32x32x16_bf16 v[180:195], v[120:123], v[104:107], v[180:195]
    v_mfma_f32_32x32x16_bf16 v[180:195], v[124:127], v[108:111], v[180:195]
    v_mfma_f32_32x32x16_bf16 v[180:195], v[128:131], v[112:115], v[180:195]
    v_mfma_f32_32x32x16_bf16 v[196:211], v[132:135], v[100:103], v[196:211]
    v_mfma_f32_32x32x16_bf16 v[196:211], v[136:139], v[104:107], v[196:211]
    v_mfma_f32_32x32x16_bf16 v[196:211], v[140:143], v[108:111], v[196:211]
    v_mfma_f32_32x32x16_bf16 v[196:211], v[144:147], v[112:115], v[196:211]
    v_mfma_f32_32x32x16_bf16 v[212:227], v[148:151], v[100:103], v[212:227]
    v_mfma_f32_32x32x16_bf16 v[212:227], v[152:155], v[104:107], v[212:227]
    v_mfma_f32_32x32x16_bf16 v[212:227], v[156:159], v[108:111], v[212:227]
    v_mfma_f32_32x32x16_bf16 v[212:227], v[160:163], v[112:115], v[212:227]
    v_mfma_f32_32x32x16_bf16 v[228:243], v[164:167], v[100:103], v[228:243]
    v_mfma_f32_32x32x16_bf16 v[228:243], v[168:171], v[104:107], v[228:243]
    v_mfma_f32_32x32x16_bf16 v[228:243], v[172:175], v[108:111], v[228:243]
    v_mfma_f32_32x32x16_bf16 v[228:243], v[176:179], v[112:115], v[228:243]
    s_branch at_done
at1_doqk:
    s_waitcnt lgkmcnt(0)
    s_nop 1
    v_mfma_f32_32x32x16_bf16 v[180:195], v[116:119], v[100:103], v[180:195]
    v_mfma_f32_32x32x16_bf16 v[180:195], v[120:123], v[104:107], v[180:195]
    s_cmp_eq_u32 s42, 0
    s_cbranch_scc1 at_np17
    s_mov_b32 m0, s40
    s_nop 0
    buffer_load_dwordx4 v6, s[8:11], s27 offen offset:0 lds
at_np17:
    v_mfma_f32_32x32x16_bf16 v[180:195], v[124:127], v[108:111], v[180:195]
    v_mfma_f32_32x32x16_bf16 v[180:195], v[128:131], v[112:115], v[180:195]
    s_cmp_eq_u32 s42, 0
    s_cbranch_scc1 at_np18
    buffer_load_dwordx4 v7, s[8:11], s27 offen offset:1024 lds
at_np18:
    v_mfma_f32_32x32x16_bf16 v[196:211], v[132:135], v[100:103], v[196:211]
    v_mfma_f32_32x32x16_bf16 v[196:211], v[136:139], v[104:107], v[196:211]
    s_cmp_eq_u32 s42, 0
    s_cbranch_scc1 at_np19
    buffer_load_dwordx4 v8, s[8:11], s27 offen offset:2048 lds
at_np19:
    v_mfma_f32_32x32x16_bf16 v[196:211], v[140:143], v[108:111], v[196:211]
    v_mfma_f32_32x32x16_bf16 v[196:211], v[144:147], v[112:115], v[196:211]
    s_cmp_eq_u32 s42, 0
    s_cbranch_scc1 at_np20
    buffer_load_dwordx4 v9, s[8:11], s27 offen offset:3072 lds
at_np20:
    ds_read_b128 v[116:119], v14 offset:0
    ds_read_b128 v[120:123], v15 offset:0
    ds_read_b128 v[124:127], v16 offset:0
    ds_read_b128 v[128:131], v17 offset:0
    ds_read_b128 v[132:135], v18 offset:0
    ds_read_b128 v[136:139], v19 offset:0
    ds_read_b128 v[140:143], v20 offset:0
    ds_read_b128 v[144:147], v21 offset:0
    v_mfma_f32_32x32x16_bf16 v[212:227], v[148:151], v[100:103], v[212:227]
    v_mfma_f32_32x32x16_bf16 v[212:227], v[152:155], v[104:107], v[212:227]
    s_cmp_eq_u32 s42, 0
    s_cbranch_scc1 at_np21
    s_mov_b32 m0, s41
    s_nop 0
    buffer_load_dwordx4 v10, s[12:15], s28 offen offset:0 lds
at_np21:
    v_mfma_f32_32x32x16_bf16 v[212:227], v[156:159], v[108:111], v[212:227]
    v_mfma_f32_32x32x16_bf16 v[212:227], v[160:163], v[112:115], v[212:227]
    s_cmp_eq_u32 s42, 0
    s_cbranch_scc1 at_np22
    buffer_load_dwordx4 v11, s[12:15], s28 offen offset:1024 lds
at_np22:
    v_mfma_f32_32x32x16_bf16 v[228:243], v[164:167], v[100:103], v[228:243]
    v_mfma_f32_32x32x16_bf16 v[228:243], v[168:171], v[104:107], v[228:243]
    s_cmp_eq_u32 s42, 0
    s_cbranch_scc1 at_np23
    buffer_load_dwordx4 v12, s[12:15], s28 offen offset:2048 lds
at_np23:
    v_mfma_f32_32x32x16_bf16 v[228:243], v[172:175], v[108:111], v[228:243]
    v_mfma_f32_32x32x16_bf16 v[228:243], v[176:179], v[112:115], v[228:243]
    s_cmp_eq_u32 s42, 0
    s_cbranch_scc1 at_np24
    buffer_load_dwordx4 v13, s[12:15], s28 offen offset:3072 lds
    s_add_u32 s27, s27, 32768
    s_add_u32 s28, s28, 32768
    s_xor_b32 s29, s29, 32768
    s_add_u32 s37, s37, 32768
    s_cmp_eq_u32 s37, 98304
    s_cselect_b32 s37, 0, s37
at_np24:
    ds_read_b128 v[148:151], v14 offset:8192
    ds_read_b128 v[152:155], v15 offset:8192
    ds_read_b128 v[156:159], v16 offset:8192
    ds_read_b128 v[160:163], v17 offset:8192
    ds_read_b128 v[164:167], v18 offset:8192
    ds_read_b128 v[168:171], v19 offset:8192
    ds_read_b128 v[172:175], v20 offset:8192
    ds_read_b128 v[176:179], v21 offset:8192
    s_waitcnt lgkmcnt(8)
    v_mfma_f32_32x32x16_bf16 v[68:83], v[116:119], v[36:39], 0
    v_mfma_f32_32x32x16_bf16 v[68:83], v[120:123], v[40:43], v[68:83]
    v_mfma_f32_32x32x16_bf16 v[68:83], v[124:127], v[44:47], v[68:83]
    v_mfma_f32_32x32x16_bf16 v[68:83], v[128:131], v[48:51], v[68:83]
    v_mfma_f32_32x32x16_bf16 v[68:83], v[132:135], v[52:55], v[68:83]
    v_mfma_f32_32x32x16_bf16 v[68:83], v[136:139], v[56:59], v[68:83]
    v_mfma_f32_32x32x16_bf16 v[68:83], v[140:143], v[60:63], v[68:83]
    v_mfma_f32_32x32x16_bf16 v[68:83], v[144:147], v[64:67], v[68:83]
    s_waitcnt lgkmcnt(0)
    v_mfma_f32_32x32x16_bf16 v[84:99], v[148:151], v[36:39], 0
    v_mfma_f32_32x32x16_bf16 v[84:99], v[152:155], v[40:43], v[84:99]
    v_mfma_f32_32x32x16_bf16 v[84:99], v[156:159], v[44:47], v[84:99]
    v_mfma_f32_32x32x16_bf16 v[84:99], v[160:163], v[48:51], v[84:99]
    v_mfma_f32_32x32x16_bf16 v[84:99], v[164:167], v[52:55], v[84:99]
    v_mfma_f32_32x32x16_bf16 v[84:99], v[168:171], v[56:59], v[84:99]
    v_mfma_f32_32x32x16_bf16 v[84:99], v[172:175], v[60:63], v[84:99]
    v_mfma_f32_32x32x16_bf16 v[84:99], v[176:179], v[64:67], v[84:99]
    v_xor_b32 v14, 0x8000, v14
    v_xor_b32 v15, 0x8000, v15
    v_xor_b32 v16, 0x8000, v16
    v_xor_b32 v17, 0x8000, v17
    v_xor_b32 v18, 0x8000, v18
    v_xor_b32 v19, 0x8000, v19
    v_xor_b32 v20, 0x8000, v20
    v_xor_b32 v21, 0x8000, v21
    s_xor_b32 s38, s38, 32768
    s_branch at1_next
at1_first:
    s_cmp_eq_u32 s42, 0
    s_cbranch_scc1 at_np25
    s_mov_b32 m0, s40
    s_nop 0
    buffer_load_dwordx4 v6, s[8:11], s27 offen offset:0 lds
at_np25:
    s_cmp_eq_u32 s42, 0
    s_cbranch_scc1 at_np26
    buffer_load_dwordx4 v7, s[8:11], s27 offen offset:1024 lds
at_np26:
    s_cmp_eq_u32 s42, 0
    s_cbranch_scc1 at_np27
    buffer_load_dwordx4 v8, s[8:11], s27 offen offset:2048 lds
at_np27:
    s_cmp_eq_u32 s42, 0
    s_cbranch_scc1 at_np28
    buffer_load_dwordx4 v9, s[8:11], s27 offen offset:3072 lds
at_np28:
    s_cmp_eq_u32 s42, 0
    s_cbranch_scc1 at_np29
    s_mov_b32 m0, s41
    s_nop 0
    buffer_load_dwordx4 v10, s[12:15], s28 offen offset:0 lds
at_np29:
    s_cmp_eq_u32 s42, 0
    s_cbranch_scc1 at_np30
    buffer_load_dwordx4 v11, s[12:15], s28 offen offset:1024 lds
at_np30:
    s_cmp_eq_u32 s42, 0
    s_cbranch_scc1 at_np31
    buffer_load_dwordx4 v12, s[12:15], s28 offen offset:2048 lds
at_np31:
    s_cmp_eq_u32 s42, 0
    s_cbranch_scc1 at_np32
    buffer_load_dwordx4 v13, s[12:15], s28 offen offset:3072 lds
    s_add_u32 s27, s27, 32768
    s_add_u32 s28, s28, 32768
    s_xor_b32 s29, s29, 32768
    s_add_u32 s37, s37, 32768
    s_cmp_eq_u32 s37, 98304
    s_cselect_b32 s37, 0, s37
at_np32:
    s_cmp_lg_u32 s26, s25
    s_cbranch_scc1 at1_doqk0
    s_cmp_lt_u32 s22, 2
    s_cbranch_scc1 at_done
at1_doqk0:
    ds_read_b128 v[116:119], v14 offset:0
    ds_read_b128 v[120:123], v15 offset:0
    ds_read_b128 v[124:127], v16 offset:0
    ds_read_b128 v[128:131], v17 offset:0
    ds_read_b128 v[132:135], v18 offset:0
    ds_read_b128 v[136:139], v19 offset:0
    ds_read_b128 v[140:143], v20 offset:0
    ds_read_b128 v[144:147], v21 offset:0
    ds_read_b128 v[148:151], v14 offset:8192
    ds_read_b128 v[152:155], v15 offset:8192
    ds_read_b128 v[156:159], v16 offset:8192
    ds_read_b128 v[160:163], v17 offset:8192
    ds_read_b128 v[164:167], v18 offset:8192
    ds_read_b128 v[168:171], v19 offset:8192
    ds_read_b128 v[172:175], v20 offset:8192
    ds_read_b128 v[176:179], v21 offset:8192
    s_waitcnt lgkmcnt(8)
    v_mfma_f32_32x32x16_bf16 v[68:83], v[116:119], v[36:39], 0
    v_mfma_f32_32x32x16_bf16 v[68:83], v[120:123], v[40:43], v[68:83]
    v_mfma_f32_32x32x16_bf16 v[68:83], v[124:127], v[44:47], v[68:83]
    v_mfma_f32_32x32x16_bf16 v[68:83], v[128:131], v[48:51], v[68:83]
    v_mfma_f32_32x32x16_bf16 v[68:83], v[132:135], v[52:55], v[68:83]
    v_mfma_f32_32x32x16_bf16 v[68:83], v[136:139], v[56:59], v[68:83]
    v_mfma_f32_32x32x16_bf16 v[68:83], v[140:143], v[60:63], v[68:83]
    v_mfma_f32_32x32x16_bf16 v[68:83], v[144:147], v[64:67], v[68:83]
    s_waitcnt lgkmcnt(0)
    v_mfma_f32_32x32x16_bf16 v[84:99], v[148:151], v[36:39], 0
    v_mfma_f32_32x32x16_bf16 v[84:99], v[152:155], v[40:43], v[84:99]
    v_mfma_f32_32x32x16_bf16 v[84:99], v[156:159], v[44:47], v[84:99]
    v_mfma_f32_32x32x16_bf16 v[84:99], v[160:163], v[48:51], v[84:99]
    v_mfma_f32_32x32x16_bf16 v[84:99], v[164:167], v[52:55], v[84:99]
    v_mfma_f32_32x32x16_bf16 v[84:99], v[168:171], v[56:59], v[84:99]
    v_mfma_f32_32x32x16_bf16 v[84:99], v[172:175], v[60:63], v[84:99]
    v_mfma_f32_32x32x16_bf16 v[84:99], v[176:179], v[64:67], v[84:99]
    v_xor_b32 v14, 0x8000, v14
    v_xor_b32 v15, 0x8000, v15
    v_xor_b32 v16, 0x8000, v16
    v_xor_b32 v17, 0x8000, v17
    v_xor_b32 v18, 0x8000, v18
    v_xor_b32 v19, 0x8000, v19
    v_xor_b32 v20, 0x8000, v20
    v_xor_b32 v21, 0x8000, v21
    s_xor_b32 s38, s38, 32768
at1_next:
    s_add_u32 s26, s26, 1
    s_cmp_le_u32 s26, s25
    s_cbranch_scc1 at1_loop
    s_nop 15
    v_mov_b32 v32, 0xf149f2ca
    v_cmp_gt_i32 vcc, 0, v28
    s_nop 1
    v_cndmask_b32 v68, v68, v32, vcc
    v_cmp_gt_i32 vcc, 1, v28
    s_nop 1
    v_cndmask_b32 v69, v69, v32, vcc
    v_cmp_gt_i32 vcc, 2, v28
    s_nop 1
    v_cndmask_b32 v70, v70, v32, vcc
    v_cmp_gt_i32 vcc, 3, v28
    s_nop 1
    v_cndmask_b32 v71, v71, v32, vcc
    v_cmp_gt_i32 vcc, 8, v28
    s_nop 1
    v_cndmask_b32 v72, v72, v32, vcc
    v_cmp_gt_i32 vcc, 9, v28
    s_nop 1
    v_cndmask_b32 v73, v73, v32, vcc
    v_cmp_gt_i32 vcc, 10, v28
    s_nop 1
    v_cndmask_b32 v74, v74, v32, vcc
    v_cmp_gt_i32 vcc, 11, v28
    s_nop 1
    v_cndmask_b32 v75, v75, v32, vcc
    v_cmp_gt_i32 vcc, 16, v28
    s_nop 1
    v_cndmask_b32 v76, v76, v32, vcc
    v_cmp_gt_i32 vcc, 17, v28
    s_nop 1
    v_cndmask_b32 v77, v77, v32, vcc
    v_cmp_gt_i32 vcc, 18, v28
    s_nop 1
    v_cndmask_b32 v78, v78, v32, vcc
    v_cmp_gt_i32 vcc, 19, v28
    s_nop 1
    v_cndmask_b32 v79, v79, v32, vcc
    v_cmp_gt_i32 vcc, 24, v28
    s_nop 1
    v_cndmask_b32 v80, v80, v32, vcc
    v_cmp_gt_i32 vcc, 25, v28
    s_nop 1
    v_cndmask_b32 v81, v81, v32, vcc
    v_cmp_gt_i32 vcc, 26, v28
    s_nop 1
    v_cndmask_b32 v82, v82, v32, vcc
    v_cmp_gt_i32 vcc, 27, v28
    s_nop 1
    v_cndmask_b32 v83, v83, v32, vcc
    v_cmp_gt_i32 vcc, 32, v28
    s_nop 1
    v_cndmask_b32 v84, v84, v32, vcc
    v_cmp_gt_i32 vcc, 33, v28
    s_nop 1
    v_cndmask_b32 v85, v85, v32, vcc
    v_cmp_gt_i32 vcc, 34, v28
    s_nop 1
    v_cndmask_b32 v86, v86, v32, vcc
    v_cmp_gt_i32 vcc, 35, v28
    s_nop 1
    v_cndmask_b32 v87, v87, v32, vcc
    v_cmp_gt_i32 vcc, 40, v28
    s_nop 1
    v_cndmask_b32 v88, v88, v32, vcc
    v_cmp_gt_i32 vcc, 41, v28
    s_nop 1
    v_cndmask_b32 v89, v89, v32, vcc
    v_cmp_gt_i32 vcc, 42, v28
    s_nop 1
    v_cndmask_b32 v90, v90, v32, vcc
    v_cmp_gt_i32 vcc, 43, v28
    s_nop 1
    v_cndmask_b32 v91, v91, v32, vcc
    v_cmp_gt_i32 vcc, 48, v28
    s_nop 1
    v_cndmask_b32 v92, v92, v32, vcc
    v_cmp_gt_i32 vcc, 49, v28
    s_nop 1
    v_cndmask_b32 v93, v93, v32, vcc
    v_cmp_gt_i32 vcc, 50, v28
    s_nop 1
    v_cndmask_b32 v94, v94, v32, vcc
    v_cmp_gt_i32 vcc, 51, v28
    s_nop 1
    v_cndmask_b32 v95, v95, v32, vcc
    v_cmp_gt_i32 vcc, 56, v28
    s_nop 1
    v_cndmask_b32 v96, v96, v32, vcc
    v_cmp_gt_i32 vcc, 57, v28
    s_nop 1
    v_cndmask_b32 v97, v97, v32, vcc
    v_cmp_gt_i32 vcc, 58, v28
    s_nop 1
    v_cndmask_b32 v98, v98, v32, vcc
    v_cmp_gt_i32 vcc, 59, v28
    s_nop 1
    v_cndmask_b32 v99, v99, v32, vcc
    s_setprio 1
    v_max3_f32 v32, v68, v69, v70
    v_max3_f32 v32, v32, v71, v72
    v_max3_f32 v32, v32, v73, v74
    v_max3_f32 v32, v32, v75, v76
    v_max3_f32 v32, v32, v77, v78
    v_max3_f32 v32, v32, v79, v80
    v_max3_f32 v32, v32, v81, v82
    v_max3_f32 v32, v32, v83, v84
    v_max3_f32 v32, v32, v85, v86
    v_max3_f32 v32, v32, v87, v88
    v_max3_f32 v32, v32, v89, v90
    v_max3_f32 v32, v32, v91, v92
    v_max3_f32 v32, v32, v93, v94
    v_max3_f32 v32, v32, v95, v96
    v_max3_f32 v32, v32, v97, v98
    v_max_f32 v32, v32, v99
    v_mov_b32 v33, v32
    s_nop 1
    v_permlane32_swap_b32 v32, v33
    s_nop 1
    v_max3_f32 v32, v32, v33, v26
    v_sub_f32 v30, v26, v32
    v_mul_f32 v30, s34, v30
    v_cmp_gt_f32 vcc, -8.0, v30
    s_nop 4
    s_cbranch_vccz at1b_norescale
    v_exp_f32 v30, v30
    v_mov_b32 v26, v32
    v_mul_f32 v27, v27, v30
    v_mul_f32 v180, v180, v30
    v_mul_f32 v181, v181, v30
    v_mul_f32 v182, v182, v30
    v_mul_f32 v183, v183, v30
    v_mul_f32 v184, v184, v30
    v_mul_f32 v185, v185, v30
    v_mul_f32 v186, v186, v30
    v_mul_f32 v187, v187, v30
    v_mul_f32 v188, v188, v30
    v_mul_f32 v189, v189, v30
    v_mul_f32 v190, v190, v30
    v_mul_f32 v191, v191, v30
    v_mul_f32 v192, v192, v30
    v_mul_f32 v193, v193, v30
    v_mul_f32 v194, v194, v30
    v_mul_f32 v195, v195, v30
    v_mul_f32 v196, v196, v30
    v_mul_f32 v197, v197, v30
    v_mul_f32 v198, v198, v30
    v_mul_f32 v199, v199, v30
    v_mul_f32 v200, v200, v30
    v_mul_f32 v201, v201, v30
    v_mul_f32 v202, v202, v30
    v_mul_f32 v203, v203, v30
    v_mul_f32 v204, v204, v30
    v_mul_f32 v205, v205, v30
    v_mul_f32 v206, v206, v30
    v_mul_f32 v207, v207, v30
    v_mul_f32 v208, v208, v30
    v_mul_f32 v209, v209, v30
    v_mul_f32 v210, v210, v30
    v_mul_f32 v211, v211, v30
    v_mul_f32 v212, v212, v30
    v_mul_f32 v213, v213, v30
    v_mul_f32 v214, v214, v30
    v_mul_f32 v215, v215, v30
    v_mul_f32 v216, v216, v30
    v_mul_f32 v217, v217, v30
    v_mul_f32 v218, v218, v30
    v_mul_f32 v219, v219, v30
    v_mul_f32 v220, v220, v30
    v_mul_f32 v221, v221, v30
    v_mul_f32 v222, v222, v30
    v_mul_f32 v223, v223, v30
    v_mul_f32 v224, v224, v30
    v_mul_f32 v225, v225, v30
    v_mul_f32 v226, v226, v30
    v_mul_f32 v227, v227, v30
    v_mul_f32 v228, v228, v30
    v_mul_f32 v229, v229, v30
    v_mul_f32 v230, v230, v30
    v_mul_f32 v231, v231, v30
    v_mul_f32 v232, v232, v30
    v_mul_f32 v233, v233, v30
    v_mul_f32 v234, v234, v30
    v_mul_f32 v235, v235, v30
    v_mul_f32 v236, v236, v30
    v_mul_f32 v237, v237, v30
    v_mul_f32 v238, v238, v30
    v_mul_f32 v239, v239, v30
    v_mul_f32 v240, v240, v30
    v_mul_f32 v241, v241, v30
    v_mul_f32 v242, v242, v30
    v_mul_f32 v243, v243, v30
at1b_norescale:
    v_mul_f32 v32, s34, v26
    v_sub_f32 v32, 0, v32
    v_mov_b32 v33, v32
    v_pk_fma_f32 v[68:69], v[68:69], v[34:35], v[32:33]
    v_exp_f32 v68, v68
    v_exp_f32 v69, v69
    v_pk_fma_f32 v[70:71], v[70:71], v[34:35], v[32:33]
    v_exp_f32 v70, v70
    v_exp_f32 v71, v71
    v_pk_fma_f32 v[72:73], v[72:73], v[34:35], v[32:33]
    v_exp_f32 v72, v72
    v_exp_f32 v73, v73
    v_pk_fma_f32 v[74:75], v[74:75], v[34:35], v[32:33]
    v_exp_f32 v74, v74
    v_exp_f32 v75, v75
    v_pk_fma_f32 v[76:77], v[76:77], v[34:35], v[32:33]
    v_exp_f32 v76, v76
    v_exp_f32 v77, v77
    v_pk_fma_f32 v[78:79], v[78:79], v[34:35], v[32:33]
    v_exp_f32 v78, v78
    v_exp_f32 v79, v79
    v_pk_fma_f32 v[80:81], v[80:81], v[34:35], v[32:33]
    v_exp_f32 v80, v80
    v_exp_f32 v81, v81
    v_pk_fma_f32 v[82:83], v[82:83], v[34:35], v[32:33]
    v_exp_f32 v82, v82
    v_exp_f32 v83, v83
    v_pk_fma_f32 v[84:85], v[84:85], v[34:35], v[32:33]
    v_exp_f32 v84, v84
    v_exp_f32 v85, v85
    v_pk_fma_f32 v[86:87], v[86:87], v[34:35], v[32:33]
    v_exp_f32 v86, v86
    v_exp_f32 v87, v87
    v_pk_fma_f32 v[88:89], v[88:89], v[34:35], v[32:33]
    v_exp_f32 v88, v88
    v_exp_f32 v89, v89
    v_pk_fma_f32 v[90:91], v[90:91], v[34:35], v[32:33]
    v_exp_f32 v90, v90
    v_exp_f32 v91, v91
    v_pk_fma_f32 v[92:93], v[92:93], v[34:35], v[32:33]
    v_exp_f32 v92, v92
    v_exp_f32 v93, v93
    v_pk_fma_f32 v[94:95], v[94:95], v[34:35], v[32:33]
    v_exp_f32 v94, v94
    v_exp_f32 v95, v95
    v_pk_fma_f32 v[96:97], v[96:97], v[34:35], v[32:33]
    v_exp_f32 v96, v96
    v_exp_f32 v97, v97
    v_pk_fma_f32 v[98:99], v[98:99], v[34:35], v[32:33]
    v_exp_f32 v98, v98
    v_exp_f32 v99, v99
    ds_read_b128 v[116:119], v22 offset:0
    ds_read_b128 v[120:123], v23 offset:0
    ds_read_b128 v[124:127], v24 offset:0
    ds_read_b128 v[128:131], v25 offset:0
    ds_read_b128 v[132:135], v22 offset:8192
    ds_read_b128 v[136:139], v23 offset:8192
    ds_read_b128 v[140:143], v24 offset:8192
    ds_read_b128 v[144:147], v25 offset:8192
    ds_read_b128 v[148:151], v22 offset:16384
    ds_read_b128 v[152:155], v23 offset:16384
    ds_read_b128 v[156:159], v24 offset:16384
    ds_read_b128 v[160:163], v25 offset:16384
    ds_read_b128 v[164:167], v22 offset:24576
    ds_read_b128 v[168:171], v23 offset:24576
    ds_read_b128 v[172:175], v24 offset:24576
    ds_read_b128 v[176:179], v25 offset:24576
    s_add_u32 s30, s39, 32768
    s_cmp_eq_u32 s30, 98304
    s_cselect_b32 s30, 0, s30
    s_sub_u32 s31, s30, s39
    s_mov_b32 s39, s30
    v_add_u32 v22, s31, v22
    v_add_u32 v23, s31, v23
    v_add_u32 v24, s31, v24
    v_add_u32 v25, s31, v25
    v_pk_add_f32 v[32:33], v[68:69], v[70:71]
    v_pk_add_f32 v[32:33], v[32:33], v[72:73]
    v_pk_add_f32 v[32:33], v[32:33], v[74:75]
    v_pk_add_f32 v[32:33], v[32:33], v[76:77]
    v_pk_add_f32 v[32:33], v[32:33], v[78:79]
    v_pk_add_f32 v[32:33], v[32:33], v[80:81]
    v_pk_add_f32 v[32:33], v[32:33], v[82:83]
    v_pk_add_f32 v[32:33], v[32:33], v[84:85]
    v_pk_add_f32 v[32:33], v[32:33], v[86:87]
    v_pk_add_f32 v[32:33], v[32:33], v[88:89]
    v_pk_add_f32 v[32:33], v[32:33], v[90:91]
    v_pk_add_f32 v[32:33], v[32:33], v[92:93]
    v_pk_add_f32 v[32:33], v[32:33], v[94:95]
    v_pk_add_f32 v[32:33], v[32:33], v[96:97]
    v_pk_add_f32 v[32:33], v[32:33], v[98:99]
    v_add_f32 v27, v27, v32
    v_add_f32 v27, v27, v33
    v_cvt_pk_bf16_f32 v100, v68, v69
    v_cvt_pk_bf16_f32 v101, v70, v71
    v_cvt_pk_bf16_f32 v102, v72, v73
    v_cvt_pk_bf16_f32 v103, v74, v75
    v_cvt_pk_bf16_f32 v104, v76, v77
    v_cvt_pk_bf16_f32 v105, v78, v79
    v_cvt_pk_bf16_f32 v106, v80, v81
    v_cvt_pk_bf16_f32 v107, v82, v83
    v_cvt_pk_bf16_f32 v108, v84, v85
    v_cvt_pk_bf16_f32 v109, v86, v87
    v_cvt_pk_bf16_f32 v110, v88, v89
    v_cvt_pk_bf16_f32 v111, v90, v91
    v_cvt_pk_bf16_f32 v112, v92, v93
    v_cvt_pk_bf16_f32 v113, v94, v95
    v_cvt_pk_bf16_f32 v114, v96, v97
    v_cvt_pk_bf16_f32 v115, v98, v99
    s_setprio 0
    s_waitcnt lgkmcnt(0)
    s_nop 1
    v_mfma_f32_32x32x16_bf16 v[180:195], v[116:119], v[100:103], v[180:195]
    v_mfma_f32_32x32x16_bf16 v[180:195], v[120:123], v[104:107], v[180:195]
    v_mfma_f32_32x32x16_bf16 v[180:195], v[124:127], v[108:111], v[180:195]
    v_mfma_f32_32x32x16_bf16 v[180:195], v[128:131], v[112:115], v[180:195]
    v_mfma_f32_32x32x16_bf16 v[196:211], v[132:135], v[100:103], v[196:211]
    v_mfma_f32_32x32x16_bf16 v[196:211], v[136:139], v[104:107], v[196:211]
    v_mfma_f32_32x32x16_bf16 v[196:211], v[140:143], v[108:111], v[196:211]
    v_mfma_f32_32x32x16_bf16 v[196:211], v[144:147], v[112:115], v[196:211]
    v_mfma_f32_32x32x16_bf16 v[212:227], v[148:151], v[100:103], v[212:227]
    v_mfma_f32_32x32x16_bf16 v[212:227], v[152:155], v[104:107], v[212:227]
    v_mfma_f32_32x32x16_bf16 v[212:227], v[156:159], v[108:111], v[212:227]
    v_mfma_f32_32x32x16_bf16 v[212:227], v[160:163], v[112:115], v[212:227]
    v_mfma_f32_32x32x16_bf16 v[228:243], v[164:167], v[100:103], v[228:243]
    v_mfma_f32_32x32x16_bf16 v[228:243], v[168:171], v[104:107], v[228:243]
    v_mfma_f32_32x32x16_bf16 v[228:243], v[172:175], v[108:111], v[228:243]
    v_mfma_f32_32x32x16_bf16 v[228:243], v[176:179], v[112:115], v[228:243]
at_done:
    s_sub_u32 s30, 0, s38
    v_add_u32 v14, s30, v14
    v_add_u32 v15, s30, v15
    v_add_u32 v16, s30, v16
    v_add_u32 v17, s30, v17
    v_add_u32 v18, s30, v18
    v_add_u32 v19, s30, v19
    v_add_u32 v20, s30, v20
    v_add_u32 v21, s30, v21
    s_sub_u32 s30, 0, s39
    v_add_u32 v22, s30, v22
    v_add_u32 v23, s30, v23
    v_add_u32 v24, s30, v24
    v_add_u32 v25, s30, v25
    s_nop 15
    s_nop 7
    v_mov_b32 v33, v27
    s_nop 1
    v_permlane32_swap_b32 v27, v33
    s_nop 1
    v_add_f32 v27, v27, v33
    s_barrier
    v_mov_b32 v5, v29
    s_cmp_lg_u32 s35, 0
    s_cbranch_scc1 at_nopf
    s_mov_b32 s25, s24
    s_lshl_b32 s36, s25, 7
    s_lshl_b32 s30, s22, 5
    s_add_u32 s30, s30, s36
    v_and_b32 v2, 31, v1
    v_add_u32 v2, s30, v2
    v_lshrrev_b32 v3, 5, v1
    v_lshlrev_b32 v3, 4, v3
    v_lshl_add_u32 v4, v2, 8, v3
    v_lshl_add_u32 v2, v2, 13, v3
    s_lshl_b32 s30, s23, 8
    v_add_u32 v29, s30, v2
    s_lshl_b32 s30, s23, 19
    buffer_load_dwordx4 v[36:39], v4, s[4:7], s30 offen offset:0
    buffer_load_dwordx4 v[40:43], v4, s[4:7], s30 offen offset:32
    buffer_load_dwordx4 v[44:47], v4, s[4:7], s30 offen offset:64
    buffer_load_dwordx4 v[48:51], v4, s[4:7], s30 offen offset:96
    buffer_load_dwordx4 v[52:55], v4, s[4:7], s30 offen offset:128
    buffer_load_dwordx4 v[56:59], v4, s[4:7], s30 offen offset:160
    buffer_load_dwordx4 v[60:63], v4, s[4:7], s30 offen offset:192
    buffer_load_dwordx4 v[64:67], v4, s[4:7], s30 offen offset:224
    s_lshl_b32 s27, s23, 19
    s_lshl_b32 s28, s23, 19
    s_mov_b32 s29, 0
    s_mov_b32 s37, 0
    s_mov_b32 s38, 0
    s_mov_b32 s39, 0
    s_lshl_b32 s30, s20, 12
    s_add_u32 s40, s30, s29
    s_add_u32 s41, s30, s37
    s_add_u32 s41, s41, 65536
    s_mov_b32 m0, s40
    s_nop 0
    buffer_load_dwordx4 v6, s[8:11], s27 offen offset:0 lds
    buffer_load_dwordx4 v7, s[8:11], s27 offen offset:1024 lds
    buffer_load_dwordx4 v8, s[8:11], s27 offen offset:2048 lds
    buffer_load_dwordx4 v9, s[8:11], s27 offen offset:3072 lds
    s_mov_b32 m0, s41
    s_nop 0
    buffer_load_dwordx4 v10, s[12:15], s28 offen offset:0 lds
    buffer_load_dwordx4 v11, s[12:15], s28 offen offset:1024 lds
    buffer_load_dwordx4 v12, s[12:15], s28 offen offset:2048 lds
    buffer_load_dwordx4 v13, s[12:15], s28 offen offset:3072 lds
    s_add_u32 s27, s27, 32768
    s_add_u32 s28, s28, 32768
    s_xor_b32 s29, s29, 32768
    s_add_u32 s37, s37, 32768
    s_cmp_eq_u32 s37, 98304
    s_cselect_b32 s37, 0, s37
at_nopf:
    s_lshl_b32 s30, s22, 14
    v_lshlrev_b32 v32, 4, v1
    v_add_u32 v32, s30, v32
    v_add_u32 v32, 98304, v32
    s_lshl_b32 s30, s22, 9
    v_lshlrev_b32 v33, 3, v1
    v_add_u32 v33, s30, v33
    v_add_u32 v33, 32768, v33
    s_cmp_eq_u32 s21, 0
    s_cbranch_scc1 at_merge0
    ds_write_b128 v32, v[180:183] offset:0
    ds_write_b128 v32, v[184:187] offset:1024
    ds_write_b128 v32, v[188:191] offset:2048
    ds_write_b128 v32, v[192:195] offset:3072
    ds_write_b128 v32, v[196:199] offset:4096
    ds_write_b128 v32, v[200:203] offset:5120
    ds_write_b128 v32, v[204:207] offset:6144
    ds_write_b128 v32, v[208:211] offset:7168
    ds_write_b128 v32, v[212:215] offset:8192
    ds_write_b128 v32, v[216:219] offset:9216
    ds_write_b128 v32, v[220:223] offset:10240
    ds_write_b128 v32, v[224:227] offset:11264
    ds_write_b128 v32, v[228:231] offset:12288
    ds_write_b128 v32, v[232:235] offset:13312
    ds_write_b128 v32, v[236:239] offset:14336
    ds_write_b128 v32, v[240:243] offset:15360
    ds_write_b64 v33, v[26:27]
    s_waitcnt lgkmcnt(0)
    s_barrier
    s_branch at_mergedone
at_merge0:
    s_barrier
    ds_read_b64 v[68:69], v33
    ds_read_b128 v[116:119], v32 offset:0
    ds_read_b128 v[120:123], v32 offset:1024
    ds_read_b128 v[124:127], v32 offset:2048
    ds_read_b128 v[128:131], v32 offset:3072
    ds_read_b128 v[132:135], v32 offset:4096
    ds_read_b128 v[136:139], v32 offset:5120
    ds_read_b128 v[140:143], v32 offset:6144
    ds_read_b128 v[144:147], v32 offset:7168
    ds_read_b128 v[148:151], v32 offset:8192
    ds_read_b128 v[152:155], v32 offset:9216
    ds_read_b128 v[156:159], v32 offset:10240
    ds_read_b128 v[160:163], v32 offset:11264
    ds_read_b128 v[164:167], v32 offset:12288
    ds_read_b128 v[168:171], v32 offset:13312
    ds_read_b128 v[172:175], v32 offset:14336
    ds_read_b128 v[176:179], v32 offset:15360
    s_waitcnt lgkmcnt(0)
    v_max_f32 v2, v26, v68
    v_sub_f32 v3, v26, v2
    v_sub_f32 v4, v68, v2
    v_mul_f32 v3, s34, v3
    v_mul_f32 v4, s34, v4
    v_exp_f32 v3, v3
    v_exp_f32 v4, v4
    s_nop 0
    v_mul_f32 v27, v27, v3
    v_fmac_f32 v27, v69, v4
    v_rcp_f32 v27, v27
    s_nop 0
    v_mul_f32 v3, v3, v27
    v_mul_f32 v4, v4, v27
    v_mul_f32 v180, v180, v3
    v_fmac_f32 v180, v116, v4
    v_mul_f32 v181, v181, v3
    v_fmac_f32 v181, v117, v4
    v_mul_f32 v182, v182, v3
    v_fmac_f32 v182, v118, v4
    v_mul_f32 v183, v183, v3
    v_fmac_f32 v183, v119, v4
    v_mul_f32 v184, v184, v3
    v_fmac_f32 v184, v120, v4
    v_mul_f32 v185, v185, v3
    v_fmac_f32 v185, v121, v4
    v_mul_f32 v186, v186, v3
    v_fmac_f32 v186, v122, v4
    v_mul_f32 v187, v187, v3
    v_fmac_f32 v187, v123, v4
    v_mul_f32 v188, v188, v3
    v_fmac_f32 v188, v124, v4
    v_mul_f32 v189, v189, v3
    v_fmac_f32 v189, v125, v4
    v_mul_f32 v190, v190, v3
    v_fmac_f32 v190, v126, v4
    v_mul_f32 v191, v191, v3
    v_fmac_f32 v191, v127, v4
    v_mul_f32 v192, v192, v3
    v_fmac_f32 v192, v128, v4
    v_mul_f32 v193, v193, v3
    v_fmac_f32 v193, v129, v4
    v_mul_f32 v194, v194, v3
    v_fmac_f32 v194, v130, v4
    v_mul_f32 v195, v195, v3
    v_fmac_f32 v195, v131, v4
    v_mul_f32 v196, v196, v3
    v_fmac_f32 v196, v132, v4
    v_mul_f32 v197, v197, v3
    v_fmac_f32 v197, v133, v4
    v_mul_f32 v198, v198, v3
    v_fmac_f32 v198, v134, v4
    v_mul_f32 v199, v199, v3
    v_fmac_f32 v199, v135, v4
    v_mul_f32 v200, v200, v3
    v_fmac_f32 v200, v136, v4
    v_mul_f32 v201, v201, v3
    v_fmac_f32 v201, v137, v4
    v_mul_f32 v202, v202, v3
    v_fmac_f32 v202, v138, v4
    v_mul_f32 v203, v203, v3
    v_fmac_f32 v203, v139, v4
    v_mul_f32 v204, v204, v3
    v_fmac_f32 v204, v140, v4
    v_mul_f32 v205, v205, v3
    v_fmac_f32 v205, v141, v4
    v_mul_f32 v206, v206, v3
    v_fmac_f32 v206, v142, v4
    v_mul_f32 v207, v207, v3
    v_fmac_f32 v207, v143, v4
    v_mul_f32 v208, v208, v3
    v_fmac_f32 v208, v144, v4
    v_mul_f32 v209, v209, v3
    v_fmac_f32 v209, v145, v4
    v_mul_f32 v210, v210, v3
    v_fmac_f32 v210, v146, v4
    v_mul_f32 v211, v211, v3
    v_fmac_f32 v211, v147, v4
    v_mul_f32 v212, v212, v3
    v_fmac_f32 v212, v148, v4
    v_mul_f32 v213, v213, v3
    v_fmac_f32 v213, v149, v4
    v_mul_f32 v214, v214, v3
    v_fmac_f32 v214, v150, v4
    v_mul_f32 v215, v215, v3
    v_fmac_f32 v215, v151, v4
    v_mul_f32 v216, v216, v3
    v_fmac_f32 v216, v152, v4
    v_mul_f32 v217, v217, v3
    v_fmac_f32 v217, v153, v4
    v_mul_f32 v218, v218, v3
    v_fmac_f32 v218, v154, v4
    v_mul_f32 v219, v219, v3
    v_fmac_f32 v219, v155, v4
    v_mul_f32 v220, v220, v3
    v_fmac_f32 v220, v156, v4
    v_mul_f32 v221, v221, v3
    v_fmac_f32 v221, v157, v4
    v_mul_f32 v222, v222, v3
    v_fmac_f32 v222, v158, v4
    v_mul_f32 v223, v223, v3
    v_fmac_f32 v223, v159, v4
    v_mul_f32 v224, v224, v3
    v_fmac_f32 v224, v160, v4
    v_mul_f32 v225, v225, v3
    v_fmac_f32 v225, v161, v4
    v_mul_f32 v226, v226, v3
    v_fmac_f32 v226, v162, v4
    v_mul_f32 v227, v227, v3
    v_fmac_f32 v227, v163, v4
    v_mul_f32 v228, v228, v3
    v_fmac_f32 v228, v164, v4
    v_mul_f32 v229, v229, v3
    v_fmac_f32 v229, v165, v4
    v_mul_f32 v230, v230, v3
    v_fmac_f32 v230, v166, v4
    v_mul_f32 v231, v231, v3
    v_fmac_f32 v231, v167, v4
    v_mul_f32 v232, v232, v3
    v_fmac_f32 v232, v168, v4
    v_mul_f32 v233, v233, v3
    v_fmac_f32 v233, v169, v4
    v_mul_f32 v234, v234, v3
    v_fmac_f32 v234, v170, v4
    v_mul_f32 v235, v235, v3
    v_fmac_f32 v235, v171, v4
    v_mul_f32 v236, v236, v3
    v_fmac_f32 v236, v172, v4
    v_mul_f32 v237, v237, v3
    v_fmac_f32 v237, v173, v4
    v_mul_f32 v238, v238, v3
    v_fmac_f32 v238, v174, v4
    v_mul_f32 v239, v239, v3
    v_fmac_f32 v239, v175, v4
    v_mul_f32 v240, v240, v3
    v_fmac_f32 v240, v176, v4
    v_mul_f32 v241, v241, v3
    v_fmac_f32 v241, v177, v4
    v_mul_f32 v242, v242, v3
    v_fmac_f32 v242, v178, v4
    v_mul_f32 v243, v243, v3
    v_fmac_f32 v243, v179, v4
    v_cvt_pk_bf16_f32 v68, v180, v181
    v_cvt_pk_bf16_f32 v69, v182, v183
    v_cvt_pk_bf16_f32 v70, v184, v185
    v_cvt_pk_bf16_f32 v71, v186, v187
    v_cvt_pk_bf16_f32 v72, v188, v189
    v_cvt_pk_bf16_f32 v73, v190, v191
    v_cvt_pk_bf16_f32 v74, v192, v193
    v_cvt_pk_bf16_f32 v75, v194, v195
    v_cvt_pk_bf16_f32 v76, v196, v197
    v_cvt_pk_bf16_f32 v77, v198, v199
    v_cvt_pk_bf16_f32 v78, v200, v201
    v_cvt_pk_bf16_f32 v79, v202, v203
    v_cvt_pk_bf16_f32 v80, v204, v205
    v_cvt_pk_bf16_f32 v81, v206, v207
    v_cvt_pk_bf16_f32 v82, v208, v209
    v_cvt_pk_bf16_f32 v83, v210, v211
    v_cvt_pk_bf16_f32 v84, v212, v213
    v_cvt_pk_bf16_f32 v85, v214, v215
    v_cvt_pk_bf16_f32 v86, v216, v217
    v_cvt_pk_bf16_f32 v87, v218, v219
    v_cvt_pk_bf16_f32 v88, v220, v221
    v_cvt_pk_bf16_f32 v89, v222, v223
    v_cvt_pk_bf16_f32 v90, v224, v225
    v_cvt_pk_bf16_f32 v91, v226, v227
    v_cvt_pk_bf16_f32 v92, v228, v229
    v_cvt_pk_bf16_f32 v93, v230, v231
    v_cvt_pk_bf16_f32 v94, v232, v233
    v_cvt_pk_bf16_f32 v95, v234, v235
    v_cvt_pk_bf16_f32 v96, v236, v237
    v_cvt_pk_bf16_f32 v97, v238, v239
    v_cvt_pk_bf16_f32 v98, v240, v241
    v_cvt_pk_bf16_f32 v99, v242, v243
    buffer_store_dwordx4 v[68:71], v5, s[16:19], 0 offen offset:0
    buffer_store_dwordx4 v[72:75], v5, s[16:19], 0 offen offset:32
    buffer_store_dwordx4 v[76:79], v5, s[16:19], 0 offen offset:64
    buffer_store_dwordx4 v[80:83], v5, s[16:19], 0 offen offset:96
    buffer_store_dwordx4 v[84:87], v5, s[16:19], 0 offen offset:128
    buffer_store_dwordx4 v[88:91], v5, s[16:19], 0 offen offset:160
    buffer_store_dwordx4 v[92:95], v5, s[16:19], 0 offen offset:192
    buffer_store_dwordx4 v[96:99], v5, s[16:19], 0 offen offset:224
at_mergedone:
    s_barrier
    s_add_u32 s35, s35, 1
    s_cmp_eq_u32 s35, 1
    s_cbranch_scc1 at_qblock
at_end:
    s_endpgm
.text
.globl final_kernel
.p2align 8
.type final_kernel,@function
final_kernel:
    s_cmp_ge_u32 s2, 240
    s_cbranch_scc1 fi_end
    s_load_dwordx2 s[34:35], s[0:1], 40
    s_load_dwordx2 s[36:37], s[0:1], 72
    s_load_dwordx2 s[44:45], s[0:1], 104
    s_waitcnt lgkmcnt(0)
    s_mov_b32 s4, s34
    s_mov_b32 s5, s35
    s_mov_b32 s6, 0x500000
    s_mov_b32 s7, 0x00020000
    s_add_u32 s8, s44, 0x5000000
    s_addc_u32 s9, s45, 0
    s_mov_b32 s10, 0x1000000
    s_mov_b32 s11, 0x00020000
    s_add_u32 s12, s44, 0x6000000
    s_addc_u32 s13, s45, 0
    s_mov_b32 s14, 0xf00000
    s_mov_b32 s15, 0x00020000
    s_add_u32 s56, s44, 0x4000000
    s_addc_u32 s57, s45, 0
    s_mov_b32 s58, 0x21c000
    s_mov_b32 s59, 0x00020000
    s_mov_b32 s60, s36
    s_mov_b32 s61, s37
    s_mov_b32 s62, 0x6c0000
    s_mov_b32 s63, 0x00020000
    s_and_b32 s47, s2, 7
    s_lshr_b32 s52, s2, 3
    s_lshl_b32 s47, s47, 1
    s_and_b32 s46, s52, 1
    s_add_u32 s47, s47, s46
    s_lshr_b32 s52, s52, 1
    s_mul_i32 s53, s52, 205
    s_lshr_b32 s53, s53, 10
    s_mul_i32 s46, s53, 5
    s_sub_u32 s46, s52, s46
    s_lshl_b32 s46, s46, 7
    s_lshl_b32 s47, s47, 7
    v_and_b32 v2, 63, v0
    v_lshrrev_b32 v3, 6, v0
    s_nop 0
    v_readfirstlane_b32 s20, v3
    s_nop 3
    s_and_b32 s28, s20, 1
    s_lshr_b32 s29, s20, 1
    v_mov_b32 v44, 0
    v_mov_b32 v45, 0
    v_mov_b32 v46, 0
    v_mov_b32 v47, 0
    v_mov_b32 v48, 0
    v_mov_b32 v49, 0
    v_mov_b32 v50, 0
    v_mov_b32 v51, 0
    v_mov_b32 v52, 0
    v_mov_b32 v53, 0
    v_mov_b32 v54, 0
    v_mov_b32 v55, 0
    v_mov_b32 v56, 0
    v_mov_b32 v57, 0
    v_mov_b32 v58, 0
    v_mov_b32 v59, 0
    v_mov_b32 v60, 0
    v_mov_b32 v61, 0
    v_mov_b32 v62, 0
    v_mov_b32 v63, 0
    v_mov_b32 v64, 0
    v_mov_b32 v65, 0
    v_mov_b32 v66, 0
    v_mov_b32 v67, 0
    v_mov_b32 v68, 0
    v_mov_b32 v69, 0
    v_mov_b32 v70, 0
    v_mov_b32 v71, 0
    v_mov_b32 v72, 0
    v_mov_b32 v73, 0
    v_mov_b32 v74, 0
    v_mov_b32 v75, 0
    s_cmp_eq_u32 s53, 2
    s_cbranch_scc1 fi_seg2
    s_mul_i32 s48, s53, 2621440
    s_lshl_b32 s24, s46, 1
    s_add_u32 s48, s48, s24
    s_lshl_b32 s49, s47, 13
    s_lshl_b32 s24, s53, 12
    s_add_u32 s49, s49, s24
    s_mul_i32 s24, s20, 2048
    s_add_u32 s24, s24, 0
    v_lshlrev_b32 v3, 4, v2
    v_add_u32 v3, s24, v3
    v_lshrrev_b32 v4, 8, v3
    v_and_b32 v3, 255, v3
    v_and_b32 v5, 3, v4
    v_lshlrev_b32 v5, 6, v5
    v_xor_b32 v3, v3, v5
    s_mov_b32 s25, 1280
    v_mul_lo_u32 v4, v4, s25
    v_add_u32 v6, v3, v4
    s_mul_i32 s24, s20, 2048
    s_add_u32 s24, s24, 1024
    v_lshlrev_b32 v3, 4, v2
    v_add_u32 v3, s24, v3
    v_lshrrev_b32 v4, 8, v3
    v_and_b32 v3, 255, v3
    v_and_b32 v5, 3, v4
    v_lshlrev_b32 v5, 6, v5
    v_xor_b32 v3, v3, v5
    s_mov_b32 s25, 1280
    v_mul_lo_u32 v4, v4, s25
    v_add_u32 v7, v3, v4
    v_lshrrev_b32 v3, 5, v2
    v_lshlrev_b32 v3, 2, v3
    v_bfe_u32 v4, v2, 2, 2
    v_add_u32 v3, v3, v4
    v_lshlrev_b32 v3, 8, v3
    v_bfe_u32 v5, v2, 4, 1
    v_lshlrev_b32 v5, 5, v5
    v_add_u32 v3, v3, v5
    v_and_b32 v5, 3, v2
    v_lshl_add_u32 v3, v5, 3, v3
    s_mul_i32 s24, s28, 2
    s_add_u32 s24, s24, 0
    v_xor_b32 v5, s24, v4
    v_lshl_add_u32 v10, v5, 6, v3
    s_mul_i32 s24, s28, 2
    s_add_u32 s24, s24, 1
    v_xor_b32 v5, s24, v4
    v_lshl_add_u32 v11, v5, 6, v3
    s_mul_i32 s24, s20, 16
    s_add_u32 s24, s24, 0
    v_lshrrev_b32 v3, 3, v2
    v_add_u32 v3, s24, v3
    v_bfe_u32 v4, v3, 1, 3
    v_and_b32 v5, 7, v2
    v_xor_b32 v4, v4, v5
    s_mov_b32 s25, 8192
    v_mul_lo_u32 v3, v3, s25
    v_lshl_add_u32 v8, v4, 4, v3
    s_mul_i32 s24, s20, 16
    s_add_u32 s24, s24, 8
    v_lshrrev_b32 v3, 3, v2
    v_add_u32 v3, s24, v3
    v_bfe_u32 v4, v3, 1, 3
    v_and_b32 v5, 7, v2
    v_xor_b32 v4, v4, v5
    s_mov_b32 s25, 8192
    v_mul_lo_u32 v3, v3, s25
    v_lshl_add_u32 v9, v4, 4, v3
    s_mul_i32 s24, s29, 32
    v_and_b32 v3, 31, v2
    v_add_u32 v3, s24, v3
    v_bfe_u32 v4, v3, 1, 3
    v_lshrrev_b32 v5, 5, v2
    v_lshlrev_b32 v3, 7, v3
    v_add_u32 v14, 0, v5
    v_xor_b32 v14, v14, v4
    v_lshl_add_u32 v14, v14, 4, v3
    v_add_u32 v14, 16384, v14
    v_add_u32 v15, 2, v5
    v_xor_b32 v15, v15, v4
    v_lshl_add_u32 v15, v15, 4, v3
    v_add_u32 v15, 16384, v15
    v_add_u32 v16, 4, v5
    v_xor_b32 v16, v16, v4
    v_lshl_add_u32 v16, v16, 4, v3
    v_add_u32 v16, 16384, v16
    v_add_u32 v17, 6, v5
    v_xor_b32 v17, v17, v4
    v_lshl_add_u32 v17, v17, 4, v3
    v_add_u32 v17, 16384, v17
    s_mov_b32 s22, s48
    s_mov_b32 s23, s49
    s_mov_b32 s30, 0
    s_mov_b32 s31, 0
    s_mul_i32 s27, s20, 2048
    s_add_u32 s27, s27, s30
    s_add_u32 m0, s27, 0
    s_nop 0
    buffer_load_dwordx4 v6, s[4:7], s22 offen lds
    s_add_u32 m0, s27, 1024
    s_nop 0
    buffer_load_dwordx4 v7, s[4:7], s22 offen lds
    s_mul_i32 s27, s20, 2048
    s_add_u32 s27, s27, s30
    s_add_u32 m0, s27, 16384
    s_nop 0
    buffer_load_dwordx4 v8, s[8:11], s23 offen lds
    s_add_u32 m0, s27, 17408
    s_nop 0
    buffer_load_dwordx4 v9, s[8:11], s23 offen lds
    s_add_u32 s22, s22, 81920
    s_add_u32 s23, s23, 128
    s_add_u32 s30, s30, 32768
    s_cmp_eq_u32 s30, 131072
    s_cselect_b32 s30, 0, s30
    s_mul_i32 s27, s20, 2048
    s_add_u32 s27, s27, s30
    s_add_u32 m0, s27, 0
    s_nop 0
    buffer_load_dwordx4 v6, s[4:7], s22 offen lds
    s_add_u32 m0, s27, 1024
    s_nop 0
    buffer_load_dwordx4 v7, s[4:7], s22 offen lds
    s_mul_i32 s27, s20, 2048
    s_add_u32 s27, s27, s30
    s_add_u32 m0, s27, 16384
    s_nop 0
    buffer_load_dwordx4 v8, s[8:11], s23 offen lds
    s_add_u32 m0, s27, 17408
    s_nop 0
    buffer_load_dwordx4 v9, s[8:11], s23 offen lds
    s_add_u32 s22, s22, 81920
    s_add_u32 s23, s23, 128
    s_add_u32 s30, s30, 32768
    s_cmp_eq_u32 s30, 131072
    s_cselect_b32 s30, 0, s30
    s_mul_i32 s27, s20, 2048
    s_add_u32 s27, s27, s30
    s_add_u32 m0, s27, 0
    s_nop 0
    buffer_load_dwordx4 v6, s[4:7], s22 offen lds
    s_add_u32 m0, s27, 1024
    s_nop 0
    buffer_load_dwordx4 v7, s[4:7], s22 offen lds
    s_mul_i32 s27, s20, 2048
    s_add_u32 s27, s27, s30
    s_add_u32 m0, s27, 16384
    s_nop 0
    buffer_load_dwordx4 v8, s[8:11], s23 offen lds
    s_add_u32 m0, s27, 17408
    s_nop 0
    buffer_load_dwordx4 v9, s[8:11], s23 offen lds
    s_add_u32 s22, s22, 81920
    s_add_u32 s23, s23, 128
    s_add_u32 s30, s30, 32768
    s_cmp_eq_u32 s30, 131072
    s_cselect_b32 s30, 0, s30
    s_waitcnt vmcnt(8)
    s_barrier
    ds_read_b64_tr_b16 v[20:21], v10 offset:0
    ds_read_b64_tr_b16 v[22:23], v10 offset:2048
    ds_read_b64_tr_b16 v[24:25], v11 offset:0
    ds_read_b64_tr_b16 v[26:27], v11 offset:2048
    ds_read_b128 v[36:39], v14 offset:0
    s_mov_b32 s21, 29
fi_s1_loop:
    s_waitcnt vmcnt(4)
    s_barrier
    ds_read_b64_tr_b16 v[28:29], v10 offset:4096
    ds_read_b64_tr_b16 v[30:31], v10 offset:6144
    ds_read_b64_tr_b16 v[32:33], v11 offset:4096
    ds_read_b64_tr_b16 v[34:35], v11 offset:6144
    ds_read_b128 v[40:43], v15 offset:0
    s_waitcnt lgkmcnt(5)
    v_mfma_f32_32x32x16_bf16 v[44:59], v[20:23], v[36:39], v[44:59]
    s_mul_i32 s27, s20, 2048
    s_add_u32 s27, s27, s30
    s_add_u32 m0, s27, 0
    s_nop 0
    buffer_load_dwordx4 v6, s[4:7], s22 offen lds
    v_mfma_f32_32x32x16_bf16 v[60:75], v[24:27], v[36:39], v[60:75]
    s_add_u32 m0, s27, 1024
    s_nop 0
    buffer_load_dwordx4 v7, s[4:7], s22 offen lds
    ds_read_b64_tr_b16 v[20:21], v10 offset:8192
    ds_read_b64_tr_b16 v[22:23], v10 offset:10240
    ds_read_b64_tr_b16 v[24:25], v11 offset:8192
    ds_read_b64_tr_b16 v[26:27], v11 offset:10240
    ds_read_b128 v[36:39], v16 offset:0
    s_waitcnt lgkmcnt(5)
    v_mfma_f32_32x32x16_bf16 v[44:59], v[28:31], v[40:43], v[44:59]
    s_mul_i32 s27, s20, 2048
    s_add_u32 s27, s27, s30
    s_add_u32 m0, s27, 16384
    s_nop 0
    buffer_load_dwordx4 v8, s[8:11], s23 offen lds
    v_mfma_f32_32x32x16_bf16 v[60:75], v[32:35], v[40:43], v[60:75]
    s_add_u32 m0, s27, 17408
    s_nop 0
    buffer_load_dwordx4 v9, s[8:11], s23 offen lds
    s_add_u32 s22, s22, 81920
    s_add_u32 s23, s23, 128
    s_add_u32 s30, s30, 32768
    s_cmp_eq_u32 s30, 131072
    s_cselect_b32 s30, 0, s30
    ds_read_b64_tr_b16 v[28:29], v10 offset:12288
    ds_read_b64_tr_b16 v[30:31], v10 offset:14336
    ds_read_b64_tr_b16 v[32:33], v11 offset:12288
    ds_read_b64_tr_b16 v[34:35], v11 offset:14336
    ds_read_b128 v[40:43], v17 offset:0
    s_waitcnt lgkmcnt(5)
    v_mfma_f32_32x32x16_bf16 v[44:59], v[20:23], v[36:39], v[44:59]
    v_mfma_f32_32x32x16_bf16 v[60:75], v[24:27], v[36:39], v[60:75]
    s_waitcnt lgkmcnt(0)
    v_mfma_f32_32x32x16_bf16 v[44:59], v[28:31], v[40:43], v[44:59]
    v_mfma_f32_32x32x16_bf16 v[60:75], v[32:35], v[40:43], v[60:75]
    s_add_u32 s24, s31, 32768
    s_cmp_eq_u32 s24, 131072
    s_cselect_b32 s24, 0, s24
    s_sub_u32 s25, s24, s31
    s_mov_b32 s31, s24
    v_add_u32 v10, s25, v10
    v_add_u32 v11, s25, v11
    v_add_u32 v14, s25, v14
    v_add_u32 v15, s25, v15
    v_add_u32 v16, s25, v16
    v_add_u32 v17, s25, v17
    ds_read_b64_tr_b16 v[20:21], v10 offset:0
    ds_read_b64_tr_b16 v[22:23], v10 offset:2048
    ds_read_b64_tr_b16 v[24:25], v11 offset:0
    ds_read_b64_tr_b16 v[26:27], v11 offset:2048
    ds_read_b128 v[36:39], v14 offset:0
    s_sub_u32 s21, s21, 1
    s_cmp_lg_u32 s21, 0
    s_cbranch_scc1 fi_s1_loop
    s_waitcnt vmcnt(4)
    s_barrier
    ds_read_b64_tr_b16 v[28:29], v10 offset:4096
    ds_read_b64_tr_b16 v[30:31], v10 offset:6144
    ds_read_b64_tr_b16 v[32:33], v11 offset:4096
    ds_read_b64_tr_b16 v[34:35], v11 offset:6144
    ds_read_b128 v[40:43], v15 offset:0
    s_waitcnt lgkmcnt(5)
    v_mfma_f32_32x32x16_bf16 v[44:59], v[20:23], v[36:39], v[44:59]
    v_mfma_f32_32x32x16_bf16 v[60:75], v[24:27], v[36:39], v[60:75]
    ds_read_b64_tr_b16 v[20:21], v10 offset:8192
    ds_read_b64_tr_b16 v[22:23], v10 offset:10240
    ds_read_b64_tr_b16 v[24:25], v11 offset:8192
    ds_read_b64_tr_b16 v[26:27], v11 offset:10240
    ds_read_b128 v[36:39], v16 offset:0
    s_waitcnt lgkmcnt(5)
    v_mfma_f32_32x32x16_bf16 v[44:59], v[28:31], v[40:43], v[44:59]
    v_mfma_f32_32x32x16_bf16 v[60:75], v[32:35], v[40:43], v[60:75]
    ds_read_b64_tr_b16 v[28:29], v10 offset:12288
    ds_read_b64_tr_b16 v[30:31], v10 offset:14336
    ds_read_b64_tr_b16 v[32:33], v11 offset:12288
    ds_read_b64_tr_b16 v[34:35], v11 offset:14336
    ds_read_b128 v[40:43], v17 offset:0
    s_waitcnt lgkmcnt(5)
    v_mfma_f32_32x32x16_bf16 v[44:59], v[20:23], v[36:39], v[44:59]
    v_mfma_f32_32x32x16_bf16 v[60:75], v[24:27], v[36:39], v[60:75]
    s_waitcnt lgkmcnt(0)
    v_mfma_f32_32x32x16_bf16 v[44:59], v[28:31], v[40:43], v[44:59]
    v_mfma_f32_32x32x16_bf16 v[60:75], v[32:35], v[40:43], v[60:75]
    s_add_u32 s24, s31, 32768
    s_cmp_eq_u32 s24, 131072
    s_cselect_b32 s24, 0, s24
    s_sub_u32 s25, s24, s31
    s_mov_b32 s31, s24
    v_add_u32 v10, s25, v10
    v_add_u32 v11, s25, v11
    v_add_u32 v14, s25, v14
    v_add_u32 v15, s25, v15
    v_add_u32 v16, s25, v16
    v_add_u32 v17, s25, v17
    ds_read_b64_tr_b16 v[20:21], v10 offset:0
    ds_read_b64_tr_b16 v[22:23], v10 offset:2048
    ds_read_b64_tr_b16 v[24:25], v11 offset:0
    ds_read_b64_tr_b16 v[26:27], v11 offset:2048
    ds_read_b128 v[36:39], v14 offset:0
    s_waitcnt vmcnt(0)
    s_barrier
    ds_read_b64_tr_b16 v[28:29], v10 offset:4096
    ds_read_b64_tr_b16 v[30:31], v10 offset:6144
    ds_read_b64_tr_b16 v[32:33], v11 offset:4096
    ds_read_b64_tr_b16 v[34:35], v11 offset:6144
    ds_read_b128 v[40:43], v15 offset:0
    s_waitcnt lgkmcnt(5)
    v_mfma_f32_32x32x16_bf16 v[44:59], v[20:23], v[36:39], v[44:59]
    v_mfma_f32_32x32x16_bf16 v[60:75], v[24:27], v[36:39], v[60:75]
    ds_read_b64_tr_b16 v[20:21], v10 offset:8192
    ds_read_b64_tr_b16 v[22:23], v10 offset:10240
    ds_read_b64_tr_b16 v[24:25], v11 offset:8192
    ds_read_b64_tr_b16 v[26:27], v11 offset:10240
    ds_read_b128 v[36:39], v16 offset:0
    s_waitcnt lgkmcnt(5)
    v_mfma_f32_32x32x16_bf16 v[44:59], v[28:31], v[40:43], v[44:59]
    v_mfma_f32_32x32x16_bf16 v[60:75], v[32:35], v[40:43], v[60:75]
    ds_read_b64_tr_b16 v[28:29], v10 offset:12288
    ds_read_b64_tr_b16 v[30:31], v10 offset:14336
    ds_read_b64_tr_b16 v[32:33], v11 offset:12288
    ds_read_b64_tr_b16 v[34:35], v11 offset:14336
    ds_read_b128 v[40:43], v17 offset:0
    s_waitcnt lgkmcnt(5)
    v_mfma_f32_32x32x16_bf16 v[44:59], v[20:23], v[36:39], v[44:59]
    v_mfma_f32_32x32x16_bf16 v[60:75], v[24:27], v[36:39], v[60:75]
    s_waitcnt lgkmcnt(0)
    v_mfma_f32_32x32x16_bf16 v[44:59], v[28:31], v[40:43], v[44:59]
    v_mfma_f32_32x32x16_bf16 v[60:75], v[32:35], v[40:43], v[60:75]
    s_add_u32 s24, s31, 32768
    s_cmp_eq_u32 s24, 131072
    s_cselect_b32 s24, 0, s24
    s_sub_u32 s25, s24, s31
    s_mov_b32 s31, s24
    v_add_u32 v10, s25, v10
    v_add_u32 v11, s25, v11
    v_add_u32 v14, s25, v14
    v_add_u32 v15, s25, v15
    v_add_u32 v16, s25, v16
    v_add_u32 v17, s25, v17
    ds_read_b64_tr_b16 v[20:21], v10 offset:0
    ds_read_b64_tr_b16 v[22:23], v10 offset:2048
    ds_read_b64_tr_b16 v[24:25], v11 offset:0
    ds_read_b64_tr_b16 v[26:27], v11 offset:2048
    ds_read_b128 v[36:39], v14 offset:0
    s_waitcnt vmcnt(0)
    s_barrier
    ds_read_b64_tr_b16 v[28:29], v10 offset:4096
    ds_read_b64_tr_b16 v[30:31], v10 offset:6144
    ds_read_b64_tr_b16 v[32:33], v11 offset:4096
    ds_read_b64_tr_b16 v[34:35], v11 offset:6144
    ds_read_b128 v[40:43], v15 offset:0
    s_waitcnt lgkmcnt(5)
    v_mfma_f32_32x32x16_bf16 v[44:59], v[20:23], v[36:39], v[44:59]
    v_mfma_f32_32x32x16_bf16 v[60:75], v[24:27], v[36:39], v[60:75]
    ds_read_b64_tr_b16 v[20:21], v10 offset:8192
    ds_read_b64_tr_b16 v[22:23], v10 offset:10240
    ds_read_b64_tr_b16 v[24:25], v11 offset:8192
    ds_read_b64_tr_b16 v[26:27], v11 offset:10240
    ds_read_b128 v[36:39], v16 offset:0
    s_waitcnt lgkmcnt(5)
    v_mfma_f32_32x32x16_bf16 v[44:59], v[28:31], v[40:43], v[44:59]
    v_mfma_f32_32x32x16_bf16 v[60:75], v[32:35], v[40:43], v[60:75]
    ds_read_b64_tr_b16 v[28:29], v10 offset:12288
    ds_read_b64_tr_b16 v[30:31], v10 offset:14336
    ds_read_b64_tr_b16 v[32:33], v11 offset:12288
    ds_read_b64_tr_b16 v[34:35], v11 offset:14336
    ds_read_b128 v[40:43], v17 offset:0
    s_waitcnt lgkmcnt(5)
    v_mfma_f32_32x32x16_bf16 v[44:59], v[20:23], v[36:39], v[44:59]
    v_mfma_f32_32x32x16_bf16 v[60:75], v[24:27], v[36:39], v[60:75]
    s_waitcnt lgkmcnt(0)
    v_mfma_f32_32x32x16_bf16 v[44:59], v[28:31], v[40:43], v[44:59]
    v_mfma_f32_32x32x16_bf16 v[60:75], v[32:35], v[40:43], v[60:75]
    s_add_u32 s24, s31, 32768
    s_cmp_eq_u32 s24, 131072
    s_cselect_b32 s24, 0, s24
    s_sub_u32 s25, s24, s31
    s_mov_b32 s31, s24
    v_add_u32 v10, s25, v10
    v_add_u32 v11, s25, v11
    v_add_u32 v14, s25, v14
    v_add_u32 v15, s25, v15
    v_add_u32 v16, s25, v16
    v_add_u32 v17, s25, v17
    s_branch fi_epi
fi_seg2:
    s_mul_i32 s50, s46, 3456
    s_lshl_b32 s51, s47, 1
    s_mul_i32 s24, s20, 16
    s_add_u32 s24, s24, 0
    v_lshrrev_b32 v3, 3, v2
    v_add_u32 v3, s24, v3
    v_bfe_u32 v4, v3, 1, 3
    v_and_b32 v5, 7, v2
    v_xor_b32 v4, v4, v5
    s_mov_b32 s25, 3456
    v_mul_lo_u32 v3, v3, s25
    v_lshl_add_u32 v6, v4, 4, v3
    s_mul_i32 s24, s20, 16
    s_add_u32 s24, s24, 8
    v_lshrrev_b32 v3, 3, v2
    v_add_u32 v3, s24, v3
    v_bfe_u32 v4, v3, 1, 3
    v_and_b32 v5, 7, v2
    v_xor_b32 v4, v4, v5
    s_mov_b32 s25, 3456
    v_mul_lo_u32 v3, v3, s25
    v_lshl_add_u32 v7, v4, 4, v3
    s_mul_i32 s24, s28, 64
    v_and_b32 v3, 31, v2
    v_add_u32 v3, s24, v3
    v_bfe_u32 v4, v3, 1, 3
    v_lshrrev_b32 v5, 5, v2
    v_lshlrev_b32 v3, 7, v3
    v_add_u32 v10, 0, v5
    v_xor_b32 v10, v10, v4
    v_lshl_add_u32 v10, v10, 4, v3
    v_add_u32 v11, 2, v5
    v_xor_b32 v11, v11, v4
    v_lshl_add_u32 v11, v11, 4, v3
    v_add_u32 v12, 4, v5
    v_xor_b32 v12, v12, v4
    v_lshl_add_u32 v12, v12, 4, v3
    v_add_u32 v13, 6, v5
    v_xor_b32 v13, v13, v4
    v_lshl_add_u32 v13, v13, 4, v3
    s_mul_i32 s24, s20, 2048
    s_add_u32 s24, s24, 0
    v_lshlrev_b32 v3, 4, v2
    v_add_u32 v3, s24, v3
    v_lshrrev_b32 v4, 8, v3
    v_and_b32 v3, 255, v3
    v_and_b32 v5, 3, v4
    v_lshlrev_b32 v5, 6, v5
    v_xor_b32 v3, v3, v5
    s_mov_b32 s25, 4096
    v_mul_lo_u32 v4, v4, s25
    v_add_u32 v8, v3, v4
    s_mul_i32 s24, s20, 2048
    s_add_u32 s24, s24, 1024
    v_lshlrev_b32 v3, 4, v2
    v_add_u32 v3, s24, v3
    v_lshrrev_b32 v4, 8, v3
    v_and_b32 v3, 255, v3
    v_and_b32 v5, 3, v4
    v_lshlrev_b32 v5, 6, v5
    v_xor_b32 v3, v3, v5
    s_mov_b32 s25, 4096
    v_mul_lo_u32 v4, v4, s25
    v_add_u32 v9, v3, v4
    v_lshrrev_b32 v3, 5, v2
    v_lshlrev_b32 v3, 2, v3
    v_bfe_u32 v4, v2, 2, 2
    v_add_u32 v3, v3, v4
    v_lshlrev_b32 v3, 8, v3
    v_bfe_u32 v5, v2, 4, 1
    v_lshlrev_b32 v5, 5, v5
    v_add_u32 v3, v3, v5
    v_and_b32 v5, 3, v2
    v_lshl_add_u32 v3, v5, 3, v3
    s_mul_i32 s24, s29, 1
    s_add_u32 s24, s24, 0
    v_xor_b32 v5, s24, v4
    v_lshl_add_u32 v14, v5, 6, v3
    v_add_u32 v14, 16384, v14
    s_mov_b32 s22, s50
    s_mov_b32 s23, s51
    s_mov_b32 s30, 0
    s_mov_b32 s31, 0
    s_mul_i32 s27, s20, 2048
    s_add_u32 s27, s27, s30
    s_add_u32 m0, s27, 0
    s_nop 0
    buffer_load_dwordx4 v6, s[56:59], s22 offen lds
    s_add_u32 m0, s27, 1024
    s_nop 0
    buffer_load_dwordx4 v7, s[56:59], s22 offen lds
    s_mul_i32 s27, s20, 2048
    s_add_u32 s27, s27, s30
    s_add_u32 m0, s27, 16384
    s_nop 0
    buffer_load_dwordx4 v8, s[60:63], s23 offen lds
    s_add_u32 m0, s27, 17408
    s_nop 0
    buffer_load_dwordx4 v9, s[60:63], s23 offen lds
    s_add_u32 s22, s22, 128
    s_add_u32 s23, s23, 262144
    s_add_u32 s30, s30, 32768
    s_cmp_eq_u32 s30, 131072
    s_cselect_b32 s30, 0, s30
    s_mul_i32 s27, s20, 2048
    s_add_u32 s27, s27, s30
    s_add_u32 m0, s27, 0
    s_nop 0
    buffer_load_dwordx4 v6, s[56:59], s22 offen lds
    s_add_u32 m0, s27, 1024
    s_nop 0
    buffer_load_dwordx4 v7, s[56:59], s22 offen lds
    s_mul_i32 s27, s20, 2048
    s_add_u32 s27, s27, s30
    s_add_u32 m0, s27, 16384
    s_nop 0
    buffer_load_dwordx4 v8, s[60:63], s23 offen lds
    s_add_u32 m0, s27, 17408
    s_nop 0
    buffer_load_dwordx4 v9, s[60:63], s23 offen lds
    s_add_u32 s22, s22, 128
    s_add_u32 s23, s23, 262144
    s_add_u32 s30, s30, 32768
    s_cmp_eq_u32 s30, 131072
    s_cselect_b32 s30, 0, s30
    s_mul_i32 s27, s20, 2048
    s_add_u32 s27, s27, s30
    s_add_u32 m0, s27, 0
    s_nop 0
    buffer_load_dwordx4 v6, s[56:59], s22 offen lds
    s_add_u32 m0, s27, 1024
    s_nop 0
    buffer_load_dwordx4 v7, s[56:59], s22 offen lds
    s_mul_i32 s27, s20, 2048
    s_add_u32 s27, s27, s30
    s_add_u32 m0, s27, 16384
    s_nop 0
    buffer_load_dwordx4 v8, s[60:63], s23 offen lds
    s_add_u32 m0, s27, 17408
    s_nop 0
    buffer_load_dwordx4 v9, s[60:63], s23 offen lds
    s_add_u32 s22, s22, 128
    s_add_u32 s23, s23, 262144
    s_add_u32 s30, s30, 32768
    s_cmp_eq_u32 s30, 131072
    s_cselect_b32 s30, 0, s30
    s_waitcnt vmcnt(8)
    s_barrier
    ds_read_b128 v[20:23], v10 offset:0
    ds_read_b128 v[24:27], v10 offset:4096
    ds_read_b64_tr_b16 v[36:37], v14 offset:0
    ds_read_b64_tr_b16 v[38:39], v14 offset:2048
    s_mov_b32 s21, 24
fi_s2_loop:
    s_waitcnt vmcnt(4)
    s_barrier
    ds_read_b128 v[28:31], v11 offset:0
    ds_read_b128 v[32:35], v11 offset:4096
    ds_read_b64_tr_b16 v[40:41], v14 offset:4096
    ds_read_b64_tr_b16 v[42:43], v14 offset:6144
    s_waitcnt lgkmcnt(4)
    v_mfma_f32_32x32x16_bf16 v[44:59], v[20:23], v[36:39], v[44:59]
    s_mul_i32 s27, s20, 2048
    s_add_u32 s27, s27, s30
    s_add_u32 m0, s27, 0
    s_nop 0
    buffer_load_dwordx4 v6, s[56:59], s22 offen lds
    v_mfma_f32_32x32x16_bf16 v[60:75], v[24:27], v[36:39], v[60:75]
    s_add_u32 m0, s27, 1024
    s_nop 0
    buffer_load_dwordx4 v7, s[56:59], s22 offen lds
    ds_read_b128 v[20:23], v12 offset:0
    ds_read_b128 v[24:27], v12 offset:4096
    ds_read_b64_tr_b16 v[36:37], v14 offset:8192
    ds_read_b64_tr_b16 v[38:39], v14 offset:10240
    s_waitcnt lgkmcnt(4)
    v_mfma_f32_32x32x16_bf16 v[44:59], v[28:31], v[40:43], v[44:59]
    s_mul_i32 s27, s20, 2048
    s_add_u32 s27, s27, s30
    s_add_u32 m0, s27, 16384
    s_nop 0
    buffer_load_dwordx4 v8, s[60:63], s23 offen lds
    v_mfma_f32_32x32x16_bf16 v[60:75], v[32:35], v[40:43], v[60:75]
    s_add_u32 m0, s27, 17408
    s_nop 0
    buffer_load_dwordx4 v9, s[60:63], s23 offen lds
    s_add_u32 s22, s22, 128
    s_add_u32 s23, s23, 262144
    s_add_u32 s30, s30, 32768
    s_cmp_eq_u32 s30, 131072
    s_cselect_b32 s30, 0, s30
    ds_read_b128 v[28:31], v13 offset:0
    ds_read_b128 v[32:35], v13 offset:4096
    ds_read_b64_tr_b16 v[40:41], v14 offset:12288
    ds_read_b64_tr_b16 v[42:43], v14 offset:14336
    s_waitcnt lgkmcnt(4)
    v_mfma_f32_32x32x16_bf16 v[44:59], v[20:23], v[36:39], v[44:59]
    v_mfma_f32_32x32x16_bf16 v[60:75], v[24:27], v[36:39], v[60:75]
    s_waitcnt lgkmcnt(0)
    v_mfma_f32_32x32x16_bf16 v[44:59], v[28:31], v[40:43], v[44:59]
    v_mfma_f32_32x32x16_bf16 v[60:75], v[32:35], v[40:43], v[60:75]
    s_add_u32 s24, s31, 32768
    s_cmp_eq_u32 s24, 131072
    s_cselect_b32 s24, 0, s24
    s_sub_u32 s25, s24, s31
    s_mov_b32 s31, s24
    v_add_u32 v10, s25, v10
    v_add_u32 v11, s25, v11
    v_add_u32 v12, s25, v12
    v_add_u32 v13, s25, v13
    v_add_u32 v14, s25, v14
    ds_read_b128 v[20:23], v10 offset:0
    ds_read_b128 v[24:27], v10 offset:4096
    ds_read_b64_tr_b16 v[36:37], v14 offset:0
    ds_read_b64_tr_b16 v[38:39], v14 offset:2048
    s_sub_u32 s21, s21, 1
    s_cmp_lg_u32 s21, 0
    s_cbranch_scc1 fi_s2_loop
    s_waitcnt vmcnt(4)
    s_barrier
    ds_read_b128 v[28:31], v11 offset:0
    ds_read_b128 v[32:35], v11 offset:4096
    ds_read_b64_tr_b16 v[40:41], v14 offset:4096
    ds_read_b64_tr_b16 v[42:43], v14 offset:6144
    s_waitcnt lgkmcnt(4)
    v_mfma_f32_32x32x16_bf16 v[44:59], v[20:23], v[36:39], v[44:59]
    v_mfma_f32_32x32x16_bf16 v[60:75], v[24:27], v[36:39], v[60:75]
    ds_read_b128 v[20:23], v12 offset:0
    ds_read_b128 v[24:27], v12 offset:4096
    ds_read_b64_tr_b16 v[36:37], v14 offset:8192
    ds_read_b64_tr_b16 v[38:39], v14 offset:10240
    s_waitcnt lgkmcnt(4)
    v_mfma_f32_32x32x16_bf16 v[44:59], v[28:31], v[40:43], v[44:59]
    v_mfma_f32_32x32x16_bf16 v[60:75], v[32:35], v[40:43], v[60:75]
    ds_read_b128 v[28:31], v13 offset:0
    ds_read_b128 v[32:35], v13 offset:4096
    ds_read_b64_tr_b16 v[40:41], v14 offset:12288
    ds_read_b64_tr_b16 v[42:43], v14 offset:14336
    s_waitcnt lgkmcnt(4)
    v_mfma_f32_32x32x16_bf16 v[44:59], v[20:23], v[36:39], v[44:59]
    v_mfma_f32_32x32x16_bf16 v[60:75], v[24:27], v[36:39], v[60:75]
    s_waitcnt lgkmcnt(0)
    v_mfma_f32_32x32x16_bf16 v[44:59], v[28:31], v[40:43], v[44:59]
    v_mfma_f32_32x32x16_bf16 v[60:75], v[32:35], v[40:43], v[60:75]
    s_add_u32 s24, s31, 32768
    s_cmp_eq_u32 s24, 131072
    s_cselect_b32 s24, 0, s24
    s_sub_u32 s25, s24, s31
    s_mov_b32 s31, s24
    v_add_u32 v10, s25, v10
    v_add_u32 v11, s25, v11
    v_add_u32 v12, s25, v12
    v_add_u32 v13, s25, v13
    v_add_u32 v14, s25, v14
    ds_read_b128 v[20:23], v10 offset:0
    ds_read_b128 v[24:27], v10 offset:4096
    ds_read_b64_tr_b16 v[36:37], v14 offset:0
    ds_read_b64_tr_b16 v[38:39], v14 offset:2048
    s_waitcnt vmcnt(0)
    s_barrier
    ds_read_b128 v[28:31], v11 offset:0
    ds_read_b128 v[32:35], v11 offset:4096
    ds_read_b64_tr_b16 v[40:41], v14 offset:4096
    ds_read_b64_tr_b16 v[42:43], v14 offset:6144
    s_waitcnt lgkmcnt(4)
    v_mfma_f32_32x32x16_bf16 v[44:59], v[20:23], v[36:39], v[44:59]
    v_mfma_f32_32x32x16_bf16 v[60:75], v[24:27], v[36:39], v[60:75]
    ds_read_b128 v[20:23], v12 offset:0
    ds_read_b128 v[24:27], v12 offset:4096
    ds_read_b64_tr_b16 v[36:37], v14 offset:8192
    ds_read_b64_tr_b16 v[38:39], v14 offset:10240
    s_waitcnt lgkmcnt(4)
    v_mfma_f32_32x32x16_bf16 v[44:59], v[28:31], v[40:43], v[44:59]
    v_mfma_f32_32x32x16_bf16 v[60:75], v[32:35], v[40:43], v[60:75]
    ds_read_b128 v[28:31], v13 offset:0
    ds_read_b128 v[32:35], v13 offset:4096
    ds_read_b64_tr_b16 v[40:41], v14 offset:12288
    ds_read_b64_tr_b16 v[42:43], v14 offset:14336
    s_waitcnt lgkmcnt(4)
    v_mfma_f32_32x32x16_bf16 v[44:59], v[20:23], v[36:39], v[44:59]
    v_mfma_f32_32x32x16_bf16 v[60:75], v[24:27], v[36:39], v[60:75]
    s_waitcnt lgkmcnt(0)
    v_mfma_f32_32x32x16_bf16 v[44:59], v[28:31], v[40:43], v[44:59]
    v_mfma_f32_32x32x16_bf16 v[60:75], v[32:35], v[40:43], v[60:75]
    s_add_u32 s24, s31, 32768
    s_cmp_eq_u32 s24, 131072
    s_cselect_b32 s24, 0, s24
    s_sub_u32 s25, s24, s31
    s_mov_b32 s31, s24
    v_add_u32 v10, s25, v10
    v_add_u32 v11, s25, v11
    v_add_u32 v12, s25, v12
    v_add_u32 v13, s25, v13
    v_add_u32 v14, s25, v14
    ds_read_b128 v[20:23], v10 offset:0
    ds_read_b128 v[24:27], v10 offset:4096
    ds_read_b64_tr_b16 v[36:37], v14 offset:0
    ds_read_b64_tr_b16 v[38:39], v14 offset:2048
    s_waitcnt vmcnt(0)
    s_barrier
    ds_read_b128 v[28:31], v11 offset:0
    ds_read_b128 v[32:35], v11 offset:4096
    ds_read_b64_tr_b16 v[40:41], v14 offset:4096
    ds_read_b64_tr_b16 v[42:43], v14 offset:6144
    s_waitcnt lgkmcnt(4)
    v_mfma_f32_32x32x16_bf16 v[44:59], v[20:23], v[36:39], v[44:59]
    v_mfma_f32_32x32x16_bf16 v[60:75], v[24:27], v[36:39], v[60:75]
    ds_read_b128 v[20:23], v12 offset:0
    ds_read_b128 v[24:27], v12 offset:4096
    ds_read_b64_tr_b16 v[36:37], v14 offset:8192
    ds_read_b64_tr_b16 v[38:39], v14 offset:10240
    s_waitcnt lgkmcnt(4)
    v_mfma_f32_32x32x16_bf16 v[44:59], v[28:31], v[40:43], v[44:59]
    v_mfma_f32_32x32x16_bf16 v[60:75], v[32:35], v[40:43], v[60:75]
    ds_read_b128 v[28:31], v13 offset:0
    ds_read_b128 v[32:35], v13 offset:4096
    ds_read_b64_tr_b16 v[40:41], v14 offset:12288
    ds_read_b64_tr_b16 v[42:43], v14 offset:14336
    s_waitcnt lgkmcnt(4)
    v_mfma_f32_32x32x16_bf16 v[44:59], v[20:23], v[36:39], v[44:59]
    v_mfma_f32_32x32x16_bf16 v[60:75], v[24:27], v[36:39], v[60:75]
    s_waitcnt lgkmcnt(0)
    v_mfma_f32_32x32x16_bf16 v[44:59], v[28:31], v[40:43], v[44:59]
    v_mfma_f32_32x32x16_bf16 v[60:75], v[32:35], v[40:43], v[60:75]
    s_add_u32 s24, s31, 32768
    s_cmp_eq_u32 s24, 131072
    s_cselect_b32 s24, 0, s24
    s_sub_u32 s25, s24, s31
    s_mov_b32 s31, s24
    v_add_u32 v10, s25, v10
    v_add_u32 v11, s25, v11
    v_add_u32 v12, s25, v12
    v_add_u32 v13, s25, v13
    v_add_u32 v14, s25, v14
fi_epi:
    s_mul_i32 s24, s29, 32
    s_add_u32 s24, s24, s47
    v_and_b32 v3, 31, v2
    v_add_u32 v3, s24, v3
    s_movk_i32 s25, 2560
    v_mul_lo_u32 v3, v3, s25
    s_mul_i32 s24, s28, 64
    s_add_u32 s24, s24, s46
    s_lshl_b32 s24, s24, 2
    s_mul_i32 s25, s53, 5242880
    s_add_u32 s24, s24, s25
    v_add_u32 v3, s24, v3
    v_lshrrev_b32 v4, 5, v2
    v_lshl_add_u32 v4, v4, 4, v3
    s_nop 15
    s_nop 7
    s_mov_b32 s24, 0
    buffer_store_dwordx4 v[44:47], v4, s[12:15], s24 offen offset:0
    buffer_store_dwordx4 v[48:51], v4, s[12:15], s24 offen offset:32
    buffer_store_dwordx4 v[52:55], v4, s[12:15], s24 offen offset:64
    buffer_store_dwordx4 v[56:59], v4, s[12:15], s24 offen offset:96
    s_mov_b32 s24, 0
    buffer_store_dwordx4 v[60:63], v4, s[12:15], s24 offen offset:128
    buffer_store_dwordx4 v[64:67], v4, s[12:15], s24 offen offset:160
    buffer_store_dwordx4 v[68:71], v4, s[12:15], s24 offen offset:192
    buffer_store_dwordx4 v[72:75], v4, s[12:15], s24 offen offset:224
fi_end:
    s_endpgm
.text
.globl reduce_kernel
.p2align 8
.type reduce_kernel,@function
reduce_kernel:
    s_cmp_ge_u32 s2, 640
    s_cbranch_scc1 rd_end
    s_load_dwordx2 s[32:33], s[0:1], 0
    s_load_dwordx2 s[38:39], s[0:1], 80
    s_load_dwordx2 s[40:41], s[0:1], 88
    s_load_dwordx2 s[44:45], s[0:1], 104
    s_lshl_b32 s3, s2, 8
    v_add_u32 v1, s3, v0
    v_lshlrev_b32 v2, 4, v1
    v_lshlrev_b32 v3, 5, v1
    s_mov_b32 s4, 0x3333334
    v_mul_hi_u32 v4, v1, s4
    v_lshlrev_b32 v4, 1, v4
    s_waitcnt lgkmcnt(0)
    s_mov_b32 s8, s32
    s_mov_b32 s9, s33
    s_mov_b32 s10, 0x280000
    s_mov_b32 s11, 0x00020000
    s_mov_b32 s12, s40
    s_mov_b32 s13, s41
    s_mov_b32 s14, 0x280000
    s_mov_b32 s15, 0x00020000
    s_add_u32 s16, s44, 0x6000000
    s_addc_u32 s17, s45, 0
    s_mov_b32 s18, 0xf00000
    s_mov_b32 s19, 0x00020000
    s_mov_b32 s20, s38
    s_mov_b32 s21, s39
    s_mov_b32 s22, 0x1000
    s_mov_b32 s23, 0x00020000
    buffer_load_dwordx4 v[8:11], v2, s[8:11], 0 offen
    buffer_load_ushort v5, v4, s[20:23], 0 offen
    s_mov_b32 s24, 0
    buffer_load_dwordx4 v[12:15], v3, s[16:19], s24 offen
    buffer_load_dwordx4 v[16:19], v3, s[16:19], s24 offen offset:16
    s_mov_b32 s24, 5242880
    buffer_load_dwordx4 v[20:23], v3, s[16:19], s24 offen
    buffer_load_dwordx4 v[24:27], v3, s[16:19], s24 offen offset:16
    s_mov_b32 s24, 10485760
    buffer_load_dwordx4 v[28:31], v3, s[16:19], s24 offen
    buffer_load_dwordx4 v[32:35], v3, s[16:19], s24 offen offset:16
    s_mov_b32 s25, 0xffff0000
    s_waitcnt vmcnt(0)
    v_lshlrev_b32 v5, 16, v5
    v_add_f32 v12, v12, v20
    v_add_f32 v12, v12, v28
    v_add_f32 v12, v12, v5
    v_add_f32 v13, v13, v21
    v_add_f32 v13, v13, v29
    v_add_f32 v13, v13, v5
    v_add_f32 v14, v14, v22
    v_add_f32 v14, v14, v30
    v_add_f32 v14, v14, v5
    v_add_f32 v15, v15, v23
    v_add_f32 v15, v15, v31
    v_add_f32 v15, v15, v5
    v_add_f32 v16, v16, v24
    v_add_f32 v16, v16, v32
    v_add_f32 v16, v16, v5
    v_add_f32 v17, v17, v25
    v_add_f32 v17, v17, v33
    v_add_f32 v17, v17, v5
    v_add_f32 v18, v18, v26
    v_add_f32 v18, v18, v34
    v_add_f32 v18, v18, v5
    v_add_f32 v19, v19, v27
    v_add_f32 v19, v19, v35
    v_add_f32 v19, v19, v5
    v_lshlrev_b32 v6, 16, v8
    v_and_b32 v7, s25, v8
    v_add_f32 v6, v6, v12
    v_add_f32 v7, v7, v13
    v_cvt_pk_bf16_f32 v8, v6, v7
    v_lshlrev_b32 v6, 16, v9
    v_and_b32 v7, s25, v9
    v_add_f32 v6, v6, v14
    v_add_f32 v7, v7, v15
    v_cvt_pk_bf16_f32 v9, v6, v7
    v_lshlrev_b32 v6, 16, v10
    v_and_b32 v7, s25, v10
    v_add_f32 v6, v6, v16
    v_add_f32 v7, v7, v17
    v_cvt_pk_bf16_f32 v10, v6, v7
    v_lshlrev_b32 v6, 16, v11
    v_and_b32 v7, s25, v11
    v_add_f32 v6, v6, v18
    v_add_f32 v7, v7, v19
    v_cvt_pk_bf16_f32 v11, v6, v7
    buffer_store_dwordx4 v[8:11], v2, s[12:15], 0 offen
rd_end:
    s_endpgm
.section .rodata,"a"
.p2align 6
.amdhsa_kernel ln_kernel
  .amdhsa_next_free_vgpr 32
  .amdhsa_next_free_sgpr 96
  .amdhsa_accum_offset 32
  .amdhsa_group_segment_fixed_size 0
  .amdhsa_kernarg_size 112
  .amdhsa_user_sgpr_count 2
  .amdhsa_user_sgpr_kernarg_segment_ptr 1
  .amdhsa_system_sgpr_workgroup_id_x 1
.end_amdhsa_kernel
.section .rodata,"a"
.p2align 6
.amdhsa_kernel proj_kernel
  .amdhsa_next_free_vgpr 200
  .amdhsa_next_free_sgpr 96
  .amdhsa_accum_offset 200
  .amdhsa_group_segment_fixed_size 0
  .amdhsa_kernarg_size 112
  .amdhsa_user_sgpr_count 2
  .amdhsa_user_sgpr_kernarg_segment_ptr 1
  .amdhsa_system_sgpr_workgroup_id_x 1
.end_amdhsa_kernel
.section .rodata,"a"
.p2align 6
.amdhsa_kernel attn_kernel
  .amdhsa_next_free_vgpr 244
  .amdhsa_next_free_sgpr 96
  .amdhsa_accum_offset 244
  .amdhsa_group_segment_fixed_size 0
  .amdhsa_kernarg_size 112
  .amdhsa_user_sgpr_count 2
  .amdhsa_user_sgpr_kernarg_segment_ptr 1
  .amdhsa_system_sgpr_workgroup_id_x 1
.end_amdhsa_kernel
.section .rodata,"a"
.p2align 6
.amdhsa_kernel final_kernel
  .amdhsa_next_free_vgpr 76
  .amdhsa_next_free_sgpr 96
  .amdhsa_accum_offset 76
  .amdhsa_group_segment_fixed_size 0
  .amdhsa_kernarg_size 112
  .amdhsa_user_sgpr_count 2
  .amdhsa_user_sgpr_kernarg_segment_ptr 1
  .amdhsa_system_sgpr_workgroup_id_x 1
.end_amdhsa_kernel
.section .rodata,"a"
.p2align 6
.amdhsa_kernel reduce_kernel
  .amdhsa_next_free_vgpr 40
  .amdhsa_next_free_sgpr 96
  .amdhsa_accum_offset 40
  .amdhsa_group_segment_fixed_size 0
  .amdhsa_kernarg_size 112
  .amdhsa_user_sgpr_count 2
  .amdhsa_user_sgpr_kernarg_segment_ptr 1
  .amdhsa_system_sgpr_workgroup_id_x 1
.end_amdhsa_kernel
```
